```python
import torch

def _softmax(x, axis=-1):
    return torch.softmax(x, dim=axis)
def _gelu(x):
    return torch.nn.functional.gelu(x, approximate="tanh")
def _silu(x):
    return torch.nn.functional.silu(x)
def _sigmoid(x):
    return torch.sigmoid(x)
def _layernorm(x, axis=-1, eps=1e-5):
    m = x.mean(dim=axis, keepdim=True)
    v = x.var(dim=axis, keepdim=True, unbiased=False)
    return (x - m) / torch.sqrt(v + eps)
def _scatter_add(tgt, idx, src, axis=0):
    return tgt.clone().index_add_(axis, idx, src)
def _segment_sum(src, seg, n):
    out = torch.zeros((n,) + src.shape[1:], dtype=src.dtype)
    return out.index_add_(0, seg, src)
def _pad(x, pw):
    flat = tuple(v for pair in reversed(pw) for v in pair)
    return torch.nn.functional.pad(x, flat)

kernel_name = 'standalone__paged_block_table_kv_radixattention__sampling'

def setup_inputs():

    _w = (lambda a: (lambda t: t.to(torch.bfloat16) if t.is_floating_point() else t)(torch.as_tensor(a)))
    B, H, Hkv, Dh = 8, 16, 8, 256
    Lk = 8192
    bs = 16
    nb = max(2, Lk // bs)
    P = max(1, nb // 2)
    n_phys = P + B * (nb - P)
    shared = torch.arange(P, dtype=torch.int64)
    priv = P + torch.arange(B * (nb - P), dtype=torch.int64).reshape(B, nb - P)
    bt = torch.cat([torch.tile(shared[None, :], (B, 1)), priv], dim=1)
    ctx = nb * bs - (torch.arange(1, B + 1, dtype=torch.int64) * 2654435761) % max(1, (nb * bs - P * bs) // 2)
    return {
        "q": _w((lambda *s: torch.randn(*s, dtype=torch.bfloat16) * 0.8)(B, H, Dh)),
        "k_cache": _w((lambda *s: torch.randn(*s, dtype=torch.bfloat16) * 0.8)(n_phys, bs, Hkv, Dh)),
        "v_cache": _w((lambda *s: torch.randn(*s, dtype=torch.bfloat16) * 0.05)(n_phys, bs, Hkv, Dh)),
        "block_table": _w(bt.to(torch.int64)),
        "ctx_lens": _w(torch.as_tensor(ctx).to(torch.int64)),
    }

def reference(q, k_cache, v_cache, block_table, ctx_lens):
    B, H, Dh = q.shape
    n_phys, bs, Hkv, _ = k_cache.shape
    nb = block_table.shape[1]
    Lk = nb * bs
    rep = H // Hkv
    k = k_cache[block_table].reshape(B, Lk, Hkv, Dh)
    v = v_cache[block_table].reshape(B, Lk, Hkv, Dh)
    k = (lambda x, n, axis: torch.repeat_interleave(x, n, dim=axis))(k, rep, axis=2)
    v = (lambda x, n, axis: torch.repeat_interleave(x, n, dim=axis))(v, rep, axis=2)
    scores = torch.einsum("bhd,bkhd->bhk", q, k) * (Dh ** -0.5)
    pos = torch.arange(Lk)
    valid = pos[None, :] < ctx_lens[:, None]
    scores = torch.where(valid[:, None, :], scores, -1e9)
    p = _softmax(scores, axis=-1)
    return torch.einsum("bhk,bkhd->bhd", p, v)
```

```asm
; @launch grid=(256,1,1) block=(384,1,1) lds=152576
.amdgcn_target "amdgcn-amd-amdhsa--gfx950"
.text
.globl standalone__paged_block_table_kv_radixattention__sampling_kernel
.p2align 8
.type standalone__paged_block_table_kv_radixattention__sampling_kernel,@function
standalone__paged_block_table_kv_radixattention__sampling_kernel:
    s_cmp_ge_u32 s2, 256
    s_cbranch_scc1 L_end
    s_load_dwordx16 s[4:19], s[0:1], 0
    s_getpc_b64 s[64:65]
L_pc:
    s_lshr_b32 s29, s2, 3
    s_lshl_b32 s71, s29, 6
    s_add_u32 s71, s71, L_first-L_pc
    v_lshlrev_b32 v29, 5, v0
    v_lshrrev_b32 v28, 6, v0
    v_min_u32 v29, L_first-L_pc, v29
    v_readfirstlane_b32 s30, v28
    global_load_dword v145, v29, s[64:65]
    s_and_b32 s28, s2, 7
    v_and_b32 v1, 63, v0
    s_cmp_lg_u32 s30, 0
    s_cbranch_scc1 L_other
    s_setprio 3
    v_lshrrev_b32 v34, 5, v0
    v_and_b32 v35, 31, v0
    s_lshl_b32 s68, s28, 9
    v_lshl_add_u32 v35, v35, 4, s68
    s_mov_b32 s23, 0x20000
    v_lshl_add_u32 v4, v34, 15, v35
    v_add_u32 v5, 3040, v4
    v_add_u32 v6, 6080, v4
    v_add_u32 v7, 9120, v4
    s_lshl_b32 s24, s29, 16
    s_add_u32 s24, s24, 134217728
    s_mov_b32 s22, 150994944
    s_movk_i32 s25, 0x4000
    s_mov_b32 m0, 0
    s_waitcnt lgkmcnt(0)
    s_and_b32 s7, s7, 0xffff
    s_mov_b64 s[20:21], s[6:7]
L_lpro:
    buffer_load_dwordx4 v4, s[20:23], s24 offen offset:0 nt lds
    buffer_load_dwordx4 v5, s[20:23], s24 offen offset:1056 nt lds
    buffer_load_dwordx4 v6, s[20:23], s24 offen offset:2112 nt lds
    buffer_load_dwordx4 v7, s[20:23], s24 offen offset:3168 nt lds
    s_add_u32 s24, s24, s25
    s_sub_u32 s25, 2097152, s25
    s_add_u32 m0, m0, 4224
    s_cmp_lt_u32 m0, 33792
    s_cbranch_scc1 L_lpro
    s_load_dwordx16 s[32:47], s[64:65], s71
    s_and_b32 s9, s9, 0xffff
    s_waitcnt lgkmcnt(0)
    v_subrev_u32 v28, s38, v1
    v_or_b32 v29, 7, v28
    v_cmp_gt_u32 vcc, s41, v29
    v_bfe_u32 v29, v28, 1, 2
    v_and_b32 v30, 1, v28
    v_lshl_or_b32 v29, v30, 2, v29
    v_and_or_b32 v29, v28, -8, v29
    v_cndmask_b32 v28, v28, v29, vcc
    v_add_u32 v30, s38, v28
    v_cmp_le_u32 vcc, s40, v30
    v_add_u32 v28, s37, v30
    v_subrev_u32 v29, s41, v28
    v_cndmask_b32 v28, v28, v29, vcc
    v_cmp_gt_u32 vcc, s38, v1
    v_add_u32 v29, s36, v1
    s_nop 0
    v_cndmask_b32 v28, v28, v29, vcc
    v_cmp_gt_u32 vcc, 4, v1
    v_lshl_add_u32 v29, v1, 5, s39
    s_nop 0
    v_cndmask_b32 v28, v28, v29, vcc
    v_mov_b32 v29, 0
    v_add_u32 v30, 256, v28
    v_cmpx_le_i32 vcc, 229, v28
    v_mov_b32 v29, -283
    v_cmpx_le_i32 vcc, 431, v28
    v_mov_b32 v29, -593
    v_cmpx_le_i32 vcc, 606, v28
    v_mov_b32 v29, -930
    v_cmpx_le_i32 vcc, 754, v28
    v_mov_b32 v29, -1294
    v_cmpx_le_i32 vcc, 1003, v28
    v_mov_b32 v29, -1557
    v_cmpx_le_i32 vcc, 1225, v28
    v_mov_b32 v29, -1847
    v_cmpx_le_i32 vcc, 1420, v28
    v_mov_b32 v29, -2164
    s_mov_b64 exec, -1
    v_sub_u32 v29, v30, v29
    v_and_b32 v29, 4095, v29
    v_cmp_le_i32 vcc, 0, v28
    v_lshrrev_b32 v30, 9, v29
    v_and_b32 v29, 511, v29
    v_lshl_add_u32 v16, v30, 8, v29
    v_lshlrev_b32 v16, 16, v16
    v_mov_b32 v41, 149512
    s_mov_b32 s55, 2
    v_mov_b32 v42, s55
    ds_write_b32 v41, v42
    v_mov_b32 v144, 0
    s_mov_b32 s76, 5
    s_mov_b32 s39, 64
    s_mov_b32 s36, 64
    s_mov_b32 s37, 0
    s_mov_b32 s38, 0
    s_mov_b32 s54, 2
    s_mov_b32 s60, 16896
    s_mov_b32 s3, 0
    s_mov_b32 s53, -1
    s_branch L_lshift
L_lloop:
    s_waitcnt vmcnt(32)
    s_cmp_lg_u32 s3, 0
    s_cbranch_scc1 L_lgo
    s_waitcnt vmcnt(16)
L_lgo:
    s_barrier
    s_cmp_eq_u32 s53, s76
    s_cbranch_scc1 L_levent
L_lback:
    s_cmp_eq_u32 s36, 0
    s_cbranch_scc1 L_ldrain
    ds_read_b32 v42, v41
    s_cmp_eq_u32 s55, 5
    s_cbranch_scc1 L_ldeep
    s_cmp_lg_u32 s3, 0
    s_mov_b32 s3, 0
    s_cbranch_scc1 L_lnext
    s_cmp_eq_u32 s55, 0
    s_cbranch_scc1 L_lv0
    s_cmp_eq_u32 s55, 1
    s_cbranch_scc1 L_lv1
    s_cmp_eq_u32 s55, 2
    s_cbranch_scc1 L_lv2
    s_cmp_eq_u32 s55, 3
    s_cbranch_scc1 L_lv3
L_lfree:
    s_add_u32 m0, s60, 0
    s_mov_b32 s22, s34
    buffer_load_dwordx4 v4, s[20:23], s32 offen offset:0 nt lds
    buffer_load_dwordx4 v5, s[20:23], s32 offen offset:1056 nt lds
    buffer_load_dwordx4 v6, s[20:23], s32 offen offset:2112 nt lds
    buffer_load_dwordx4 v7, s[20:23], s32 offen offset:3168 nt lds
    s_add_u32 m0, s60, 4224
    s_add_u32 s68, s32, 16384
    buffer_load_dwordx4 v4, s[20:23], s68 offen offset:0 nt lds
    buffer_load_dwordx4 v5, s[20:23], s68 offen offset:1056 nt lds
    buffer_load_dwordx4 v6, s[20:23], s68 offen offset:2112 nt lds
    buffer_load_dwordx4 v7, s[20:23], s68 offen offset:3168 nt lds
    s_add_u32 m0, s60, 8448
    s_mov_b32 s22, s35
    buffer_load_dwordx4 v4, s[20:23], s33 offen offset:0 nt lds
    buffer_load_dwordx4 v5, s[20:23], s33 offen offset:1056 nt lds
    buffer_load_dwordx4 v6, s[20:23], s33 offen offset:2112 nt lds
    buffer_load_dwordx4 v7, s[20:23], s33 offen offset:3168 nt lds
    s_add_u32 m0, s60, 12672
    s_add_u32 s68, s33, 16384
    buffer_load_dwordx4 v4, s[20:23], s68 offen offset:0 nt lds
    buffer_load_dwordx4 v5, s[20:23], s68 offen offset:1056 nt lds
    buffer_load_dwordx4 v6, s[20:23], s68 offen offset:2112 nt lds
    buffer_load_dwordx4 v7, s[20:23], s68 offen offset:3168 nt lds
L_lshift:
    s_add_u32 s54, s54, 2
    s_cmp_ge_u32 s54, s36
    s_cbranch_scc1 L_lturn
L_lturned:
    s_add_u32 s69, s54, 1
    v_readlane_b32 s32, v16, s54
    v_readlane_b32 s33, v16, s69
    s_cmp_lt_u32 s54, s36
    s_cselect_b32 s34, 150994944, 0
    s_cmp_lt_u32 s69, s36
    s_cselect_b32 s35, 150994944, 0
    s_add_u32 s60, s60, 16896
    s_cmp_eq_u32 s60, 67584
    s_cselect_b32 s60, 0, s60
    s_bitcmp1_b32 s3, 0
    s_cbranch_scc1 L_lagain
L_lnext:
    s_waitcnt lgkmcnt(0)
    v_readfirstlane_b32 s55, v42
    s_add_u32 s53, s53, 1
    s_branch L_lloop
L_ldrain:
    s_sub_u32 s68, s39, s53
    s_cmp_le_u32 s68, 2
    s_cbranch_scc1 L_ldr1
    s_waitcnt vmcnt(16)
    s_barrier
L_ldr1:
    s_cmp_le_u32 s68, 1
    s_cbranch_scc1 L_ldr2
    s_waitcnt vmcnt(0)
    s_barrier
L_ldr2:
    s_endpgm
L_lagain:
    s_lshr_b32 s3, s3, 1
    s_branch L_lfree
L_ldeep:
    s_cmp_eq_u32 s3, 0
    s_cselect_b32 s3, 5, s3
    s_branch L_lfree
L_lv0:
    s_add_u32 m0, s60, 0
    s_mov_b32 s22, s34
    buffer_load_dwordx4 v4, s[20:23], s32 offen offset:0 nt lds
    s_waitcnt vmcnt(16)
    buffer_load_dwordx4 v5, s[20:23], s32 offen offset:1056 nt lds
    s_waitcnt vmcnt(16)
    buffer_load_dwordx4 v6, s[20:23], s32 offen offset:2112 nt lds
    s_waitcnt vmcnt(16)
    buffer_load_dwordx4 v7, s[20:23], s32 offen offset:3168 nt lds
    s_add_u32 m0, s60, 4224
    s_add_u32 s68, s32, 16384
    s_waitcnt vmcnt(16)
    buffer_load_dwordx4 v4, s[20:23], s68 offen offset:0 nt lds
    s_waitcnt vmcnt(16)
    buffer_load_dwordx4 v5, s[20:23], s68 offen offset:1056 nt lds
    s_waitcnt vmcnt(16)
    buffer_load_dwordx4 v6, s[20:23], s68 offen offset:2112 nt lds
    s_waitcnt vmcnt(16)
    buffer_load_dwordx4 v7, s[20:23], s68 offen offset:3168 nt lds
    s_add_u32 m0, s60, 8448
    s_mov_b32 s22, s35
    s_waitcnt vmcnt(16)
    buffer_load_dwordx4 v4, s[20:23], s33 offen offset:0 nt lds
    s_waitcnt vmcnt(16)
    buffer_load_dwordx4 v5, s[20:23], s33 offen offset:1056 nt lds
    s_waitcnt vmcnt(16)
    buffer_load_dwordx4 v6, s[20:23], s33 offen offset:2112 nt lds
    s_waitcnt vmcnt(16)
    buffer_load_dwordx4 v7, s[20:23], s33 offen offset:3168 nt lds
    s_add_u32 m0, s60, 12672
    s_add_u32 s68, s33, 16384
    s_waitcnt vmcnt(16)
    buffer_load_dwordx4 v4, s[20:23], s68 offen offset:0 nt lds
    s_waitcnt vmcnt(16)
    buffer_load_dwordx4 v5, s[20:23], s68 offen offset:1056 nt lds
    s_waitcnt vmcnt(16)
    buffer_load_dwordx4 v6, s[20:23], s68 offen offset:2112 nt lds
    s_waitcnt vmcnt(16)
    buffer_load_dwordx4 v7, s[20:23], s68 offen offset:3168 nt lds
    s_branch L_lshift
L_lv1:
    s_add_u32 m0, s60, 0
    s_mov_b32 s22, s34
    buffer_load_dwordx4 v4, s[20:23], s32 offen offset:0 nt lds
    buffer_load_dwordx4 v5, s[20:23], s32 offen offset:1056 nt lds
    buffer_load_dwordx4 v6, s[20:23], s32 offen offset:2112 nt lds
    s_waitcnt vmcnt(18)
    buffer_load_dwordx4 v7, s[20:23], s32 offen offset:3168 nt lds
    s_add_u32 m0, s60, 4224
    s_add_u32 s68, s32, 16384
    s_waitcnt vmcnt(18)
    buffer_load_dwordx4 v4, s[20:23], s68 offen offset:0 nt lds
    s_waitcnt vmcnt(18)
    buffer_load_dwordx4 v5, s[20:23], s68 offen offset:1056 nt lds
    s_waitcnt vmcnt(18)
    buffer_load_dwordx4 v6, s[20:23], s68 offen offset:2112 nt lds
    s_waitcnt vmcnt(18)
    buffer_load_dwordx4 v7, s[20:23], s68 offen offset:3168 nt lds
    s_add_u32 m0, s60, 8448
    s_mov_b32 s22, s35
    s_waitcnt vmcnt(18)
    buffer_load_dwordx4 v4, s[20:23], s33 offen offset:0 nt lds
    s_waitcnt vmcnt(18)
    buffer_load_dwordx4 v5, s[20:23], s33 offen offset:1056 nt lds
    s_waitcnt vmcnt(18)
    buffer_load_dwordx4 v6, s[20:23], s33 offen offset:2112 nt lds
    s_waitcnt vmcnt(18)
    buffer_load_dwordx4 v7, s[20:23], s33 offen offset:3168 nt lds
    s_add_u32 m0, s60, 12672
    s_add_u32 s68, s33, 16384
    s_waitcnt vmcnt(18)
    buffer_load_dwordx4 v4, s[20:23], s68 offen offset:0 nt lds
    s_waitcnt vmcnt(18)
    buffer_load_dwordx4 v5, s[20:23], s68 offen offset:1056 nt lds
    s_waitcnt vmcnt(18)
    buffer_load_dwordx4 v6, s[20:23], s68 offen offset:2112 nt lds
    s_waitcnt vmcnt(18)
    buffer_load_dwordx4 v7, s[20:23], s68 offen offset:3168 nt lds
    s_branch L_lshift
L_lv2:
    s_add_u32 m0, s60, 0
    s_mov_b32 s22, s34
    buffer_load_dwordx4 v4, s[20:23], s32 offen offset:0 nt lds
    buffer_load_dwordx4 v5, s[20:23], s32 offen offset:1056 nt lds
    buffer_load_dwordx4 v6, s[20:23], s32 offen offset:2112 nt lds
    buffer_load_dwordx4 v7, s[20:23], s32 offen offset:3168 nt lds
    s_add_u32 m0, s60, 4224
    s_add_u32 s68, s32, 16384
    buffer_load_dwordx4 v4, s[20:23], s68 offen offset:0 nt lds
    s_waitcnt vmcnt(20)
    buffer_load_dwordx4 v5, s[20:23], s68 offen offset:1056 nt lds
    s_waitcnt vmcnt(20)
    buffer_load_dwordx4 v6, s[20:23], s68 offen offset:2112 nt lds
    s_waitcnt vmcnt(20)
    buffer_load_dwordx4 v7, s[20:23], s68 offen offset:3168 nt lds
    s_add_u32 m0, s60, 8448
    s_mov_b32 s22, s35
    s_waitcnt vmcnt(20)
    buffer_load_dwordx4 v4, s[20:23], s33 offen offset:0 nt lds
    s_waitcnt vmcnt(20)
    buffer_load_dwordx4 v5, s[20:23], s33 offen offset:1056 nt lds
    s_waitcnt vmcnt(20)
    buffer_load_dwordx4 v6, s[20:23], s33 offen offset:2112 nt lds
    s_waitcnt vmcnt(20)
    buffer_load_dwordx4 v7, s[20:23], s33 offen offset:3168 nt lds
    s_add_u32 m0, s60, 12672
    s_add_u32 s68, s33, 16384
    s_waitcnt vmcnt(20)
    buffer_load_dwordx4 v4, s[20:23], s68 offen offset:0 nt lds
    s_waitcnt vmcnt(20)
    buffer_load_dwordx4 v5, s[20:23], s68 offen offset:1056 nt lds
    s_waitcnt vmcnt(20)
    buffer_load_dwordx4 v6, s[20:23], s68 offen offset:2112 nt lds
    s_waitcnt vmcnt(20)
    buffer_load_dwordx4 v7, s[20:23], s68 offen offset:3168 nt lds
    s_branch L_lshift
L_lv3:
    s_add_u32 m0, s60, 0
    s_mov_b32 s22, s34
    buffer_load_dwordx4 v4, s[20:23], s32 offen offset:0 nt lds
    buffer_load_dwordx4 v5, s[20:23], s32 offen offset:1056 nt lds
    buffer_load_dwordx4 v6, s[20:23], s32 offen offset:2112 nt lds
    buffer_load_dwordx4 v7, s[20:23], s32 offen offset:3168 nt lds
    s_add_u32 m0, s60, 4224
    s_add_u32 s68, s32, 16384
    buffer_load_dwordx4 v4, s[20:23], s68 offen offset:0 nt lds
    buffer_load_dwordx4 v5, s[20:23], s68 offen offset:1056 nt lds
    buffer_load_dwordx4 v6, s[20:23], s68 offen offset:2112 nt lds
    buffer_load_dwordx4 v7, s[20:23], s68 offen offset:3168 nt lds
    s_add_u32 m0, s60, 8448
    s_mov_b32 s22, s35
    s_waitcnt vmcnt(23)
    buffer_load_dwordx4 v4, s[20:23], s33 offen offset:0 nt lds
    s_waitcnt vmcnt(23)
    buffer_load_dwordx4 v5, s[20:23], s33 offen offset:1056 nt lds
    s_waitcnt vmcnt(23)
    buffer_load_dwordx4 v6, s[20:23], s33 offen offset:2112 nt lds
    s_waitcnt vmcnt(23)
    buffer_load_dwordx4 v7, s[20:23], s33 offen offset:3168 nt lds
    s_add_u32 m0, s60, 12672
    s_add_u32 s68, s33, 16384
    s_waitcnt vmcnt(23)
    buffer_load_dwordx4 v4, s[20:23], s68 offen offset:0 nt lds
    s_waitcnt vmcnt(23)
    buffer_load_dwordx4 v5, s[20:23], s68 offen offset:1056 nt lds
    s_waitcnt vmcnt(23)
    buffer_load_dwordx4 v6, s[20:23], s68 offen offset:2112 nt lds
    s_waitcnt vmcnt(23)
    buffer_load_dwordx4 v7, s[20:23], s68 offen offset:3168 nt lds
    s_branch L_lshift
L_lturn:
    s_mov_b32 s54, 0
    s_xor_b32 s38, s38, 1
    s_cselect_b64 s[20:21], s[8:9], s[6:7]
    s_cbranch_scc1 L_lturned
    v_mov_b32 v16, v17
    v_mov_b32 v17, v18
    s_min_u32 s36, s37, 64
    s_sub_u32 s37, s37, s36
    s_branch L_lturned
L_levent:
    v_mov_b32 v28, 149504
    v_lshl_add_u32 v29, v1, 2, v28
    ds_read_b128 v[30:33], v28
    ds_read_b32 v16, v29 offset:64
    ds_read_b32 v17, v29 offset:320
    ds_read_b32 v18, v29 offset:576
    s_waitcnt lgkmcnt(0)
    v_readfirstlane_b32 s52, v30
    v_readfirstlane_b32 s69, v31
    v_readfirstlane_b32 s0, v33
    s_add_u32 s39, s52, 1
    s_andn2_b32 s39, s39, 1
    s_min_u32 s36, s52, 64
    s_sub_u32 s37, s52, s36
    s_mov_b32 s76, -2
    s_cmp_eq_u32 s69, 0
    s_cbranch_scc1 L_lback
    s_waitcnt vmcnt(0)
    s_barrier
    s_mov_b32 s54, 0
    s_mov_b32 s60, 50688
    s_mov_b32 s3, 3
    s_mov_b32 s53, -1
    s_cmp_eq_u32 s52, 0
    s_cbranch_scc0 L_lturned
    s_endpgm
L_other:
    v_lshrrev_b32 v34, 5, v1
    v_and_b32 v35, 31, v0
    s_sub_u32 s70, s30, 2
    v_lshlrev_b32 v35, 4, v35
    s_lshl3_add_u32 s68, s70, s28
    v_lshl_add_u32 v35, v34, 15, v35
    s_lshl_b32 s68, s68, 10
    s_mul_i32 s70, s70, 2112
    s_add_u32 m0, s70, 124672
    s_mov_b32 s82, 65536
    s_mov_b32 s83, 0x20000
    s_waitcnt lgkmcnt(0)
    s_mov_b32 s80, s4
    s_and_b32 s81, s5, 0xffff
    s_cmp_eq_u32 s30, 1
    s_cbranch_scc1 L_noq
    buffer_load_dwordx4 v35, s[80:83], s68 offen lds
    s_add_u32 m0, m0, 544
    s_nop 0
    buffer_load_dwordx4 v35, s[80:83], s68 offen offset:512 lds
L_noq:
    s_load_dwordx16 s[32:47], s[64:65], s71
    s_mov_b32 s72, 0x00030003
    s_mov_b32 s73, 0x00030003
    s_load_dwordx8 s[20:27], s[12:13], 0
    s_mov_b32 s84, s18
    s_and_b32 s85, s19, 0xffff
    s_mov_b32 s86, 8394752
    s_mov_b32 s87, 0x20000
    s_lshl_b32 s68, s28, 8
    s_add_u32 s68, s68, 8392704
    v_and_b32 v63, 31, v0
    v_lshl_add_u32 v63, v63, 2, s68
    s_cmp_eq_u32 s30, 1
    s_cbranch_scc1 L_helper
    s_sub_u32 s30, s30, 2
    s_waitcnt lgkmcnt(0)
    v_subrev_u32 v59, 128, v0
    v_lshrrev_b32 v2, 4, v1
    v_and_b32 v34, 7, v0
    v_mul_u32_u24 v34, 1056, v34
    v_bfe_u32 v35, v0, 3, 1
    v_lshl_add_u32 v34, v35, 9, v34
    v_lshl_add_u32 v8, v2, 4, v34
    v_add_u32 v39, 124672, v8
    s_and_b32 s69, s30, 1
    s_mul_i32 s69, s69, 8448
    v_add_u32 v8, s69, v8
    v_bfe_u32 v34, v0, 2, 3
    v_mul_u32_u24 v34, 1056, v34
    v_bfe_u32 v35, v0, 5, 1
    v_lshl_add_u32 v34, v35, 9, v34
    v_and_b32 v35, 3, v0
    v_lshl_add_u32 v34, v35, 3, v34
    s_lshl_b32 s69, s30, 7
    v_add_u32 v9, s69, v34
    v_lshlrev_b32 v12, 4, v1
    v_add_u32 v12, 67584, v12
    v_subrev_u32 v28, s38, v1
    v_or_b32 v29, 7, v28
    v_cmp_gt_u32 vcc, s41, v29
    v_bfe_u32 v29, v28, 1, 2
    v_and_b32 v30, 1, v28
    v_lshl_or_b32 v29, v30, 2, v29
    v_and_or_b32 v29, v28, -8, v29
    v_cndmask_b32 v28, v28, v29, vcc
    v_add_u32 v30, s38, v28
    v_cmp_le_u32 vcc, s40, v30
    v_add_u32 v28, s37, v30
    v_subrev_u32 v29, s41, v28
    v_cndmask_b32 v28, v28, v29, vcc
    v_cmp_gt_u32 vcc, s38, v1
    v_add_u32 v29, s36, v1
    s_nop 0
    v_cndmask_b32 v28, v28, v29, vcc
    v_cmp_gt_u32 vcc, 4, v1
    v_lshl_add_u32 v29, v1, 5, s39
    s_nop 0
    v_cndmask_b32 v28, v28, v29, vcc
    v_mov_b32 v29, 0
    v_add_u32 v30, 256, v28
    v_cmpx_le_i32 vcc, 229, v28
    v_mov_b32 v29, -283
    v_cmpx_le_i32 vcc, 431, v28
    v_mov_b32 v29, -593
    v_cmpx_le_i32 vcc, 606, v28
    v_mov_b32 v29, -930
    v_cmpx_le_i32 vcc, 754, v28
    v_mov_b32 v29, -1294
    v_cmpx_le_i32 vcc, 1003, v28
    v_mov_b32 v29, -1557
    v_cmpx_le_i32 vcc, 1225, v28
    v_mov_b32 v29, -1847
    v_cmpx_le_i32 vcc, 1420, v28
    v_mov_b32 v29, -2164
    s_mov_b64 exec, -1
    v_sub_u32 v29, v30, v29
    v_and_b32 v29, 4095, v29
    v_cmp_le_i32 vcc, 0, v28
    v_lshrrev_b32 v30, 9, v29
    v_and_b32 v29, 511, v29
    v_lshl_add_u32 v30, v30, 1, 2
    v_and_b32 v30, 14, v30
    v_cndmask_b32 v30, 1, v30, vcc
    v_lshlrev_b32 v29, 4, v29
    v_lshl_add_u32 v16, v30, 16, v29
    s_mul_i32 s68, s28, 1152
    s_mul_i32 s69, s29, 9216
    s_add_u32 s68, s68, s69
    v_bfe_u32 v32, v0, 1, 3
    v_mul_u32_u24 v32, 294912, v32
    v_add_u32 v32, s68, v32
    v_and_b32 v7, 1, v0
    v_lshl_add_u32 v7, v7, 4, v32
    v_lshl_add_u32 v6, v2, 5, v7
    s_lshl_b32 s68, s30, 8
    v_add_u32 v6, s68, v6
    s_andn2_b32 s69, 3, s29
    s_lshl2_add_u32 s68, s28, s69
    s_lshl2_add_u32 s68, s68, 128
    v_mov_b32 v61, s68
    v_mov_b32 v62, 0
    v_mov_b32 v13, 0
    s_mov_b32 s50, 64
    s_mov_b32 s51, 0
    s_mov_b32 s0, 0
    s_mov_b32 s76, 5
    s_mov_b32 s62, 0x3db8aa3b
    v_mov_b32 v58, 0xff800000
    v_mov_b32 v36, 8192
    v_lshlrev_b32 v38, 2, v2
    v_mov_b32 v21, 0xff000000
    v_mul_f32 v22, s62, v21
    v_mov_b32 v23, 0
    v_mov_b32 v128, 0
    v_mov_b32 v129, 0
    v_mov_b32 v130, 0
    v_mov_b32 v131, 0
    v_mov_b32 v132, 0
    v_mov_b32 v133, 0
    v_mov_b32 v134, 0
    v_mov_b32 v135, 0
    v_mov_b32 v136, 0
    v_mov_b32 v137, 0
    v_mov_b32 v138, 0
    v_mov_b32 v139, 0
    v_mov_b32 v140, 0
    v_mov_b32 v141, 0
    v_mov_b32 v142, 0
    v_mov_b32 v143, 0
    s_waitcnt lgkmcnt(0)
    v_mov_b32 v19, s20
    s_lshl_b64 exec, s[72:73], 2
    v_mov_b32 v19, s21
    s_lshl_b64 exec, s[72:73], 4
    v_mov_b32 v19, s22
    s_lshl_b64 exec, s[72:73], 6
    v_mov_b32 v19, s23
    s_lshl_b64 exec, s[72:73], 8
    v_mov_b32 v19, s24
    s_lshl_b64 exec, s[72:73], 10
    v_mov_b32 v19, s25
    s_lshl_b64 exec, s[72:73], 12
    v_mov_b32 v19, s26
    s_lshl_b64 exec, s[72:73], 14
    v_mov_b32 v19, s27
    s_mov_b64 exec, -1
    s_mov_b64 s[26:27], -1
    v_cmp_lt_i32 vcc, 0, v19
    v_min_i32 v19, v19, v36
    s_nop 0
    v_cndmask_b32 v19, v36, v19, vcc
    v_cndmask_b32 v20, 0, -1, vcc
    s_nop 0
    v_min_u32_dpp v37, v19, v19 row_ror:2 row_mask:0xf bank_mask:0xf
    v_sub_u32 v19, v19, v38
    s_nop 0
    v_min_u32_dpp v37, v37, v37 row_ror:4 row_mask:0xf bank_mask:0xf
    s_nop 1
    v_min_u32_dpp v37, v37, v37 row_ror:8 row_mask:0xf bank_mask:0xf
    v_cmp_eq_u32 vcc, 0, v20
    v_readfirstlane_b32 s49, v37
    s_mov_b32 s53, 0
    s_mov_b32 s60, 0
    s_mov_b32 s48, 0
    s_mov_b32 s55, 0x80000000
    s_mov_b32 s54, s30
    s_mov_b32 s57, 0
    s_lshl_b32 s68, s30, 10
    v_add_u32 v11, s68, v12
    v_mov_b32 v60, v21
    v_add_u32 v10, s60, v8
    v_readlane_b32 s56, v16, s54
    s_waitcnt vmcnt(0)
    s_barrier
    ds_read_b128 v[64:67], v39 offset:0
    ds_read_b128 v[68:71], v39 offset:64
    ds_read_b128 v[72:75], v39 offset:128
    ds_read_b128 v[76:79], v39 offset:192
    ds_read_b128 v[80:83], v39 offset:256
    ds_read_b128 v[84:87], v39 offset:320
    ds_read_b128 v[88:91], v39 offset:384
    ds_read_b128 v[92:95], v39 offset:448
    s_waitcnt lgkmcnt(0)
    s_cbranch_vccz L_kin
    v_and_b32 v64, v20, v64
    v_and_b32 v65, v20, v65
    v_and_b32 v66, v20, v66
    v_and_b32 v67, v20, v67
    v_and_b32 v68, v20, v68
    v_and_b32 v69, v20, v69
    v_and_b32 v70, v20, v70
    v_and_b32 v71, v20, v71
    v_and_b32 v72, v20, v72
    v_and_b32 v73, v20, v73
    v_and_b32 v74, v20, v74
    v_and_b32 v75, v20, v75
    v_and_b32 v76, v20, v76
    v_and_b32 v77, v20, v77
    v_and_b32 v78, v20, v78
    v_and_b32 v79, v20, v79
    v_and_b32 v80, v20, v80
    v_and_b32 v81, v20, v81
    v_and_b32 v82, v20, v82
    v_and_b32 v83, v20, v83
    v_and_b32 v84, v20, v84
    v_and_b32 v85, v20, v85
    v_and_b32 v86, v20, v86
    v_and_b32 v87, v20, v87
    v_and_b32 v88, v20, v88
    v_and_b32 v89, v20, v89
    v_and_b32 v90, v20, v90
    v_and_b32 v91, v20, v91
    v_and_b32 v92, v20, v92
    v_and_b32 v93, v20, v93
    v_and_b32 v94, v20, v94
    v_and_b32 v95, v20, v95
    s_branch L_kin
L_kloop:
    s_barrier
    s_cmp_eq_u32 s53, s76
    s_cbranch_scc1 L_cmail
L_kin:
    s_sub_u32 s68, s54, s57
    s_cmp_ge_u32 s68, 2
    s_cbranch_scc1 L_kidle
    ds_read_b128 v[96:99], v10 offset:0
    ds_read_b128 v[100:103], v10 offset:64
    ds_read_b128 v[104:107], v10 offset:128
    ds_read_b128 v[108:111], v10 offset:192
    ds_read_b128 v[112:115], v10 offset:256
    ds_read_b128 v[116:119], v10 offset:320
    ds_read_b128 v[120:123], v10 offset:384
    ds_read_b128 v[124:127], v10 offset:448
    s_cmp_lt_u32 s54, s50
    s_cselect_b32 s56, s56, 0x7fff2000
    s_sub_u32 s68, s56, s55
    s_cmp_gt_u32 s68, s48
    s_cbranch_scc1 L_bias
L_biased:
    s_add_u32 s54, s54, 4
    s_waitcnt lgkmcnt(7)
    v_mfma_f32_16x16x32_bf16 v[44:47], v[96:99], v[64:67], v[24:27]
    s_waitcnt lgkmcnt(6)
    v_mfma_f32_16x16x32_bf16 v[44:47], v[100:103], v[68:71], v[44:47]
    s_waitcnt lgkmcnt(5)
    v_mfma_f32_16x16x32_bf16 v[44:47], v[104:107], v[72:75], v[44:47]
    s_waitcnt lgkmcnt(4)
    v_mfma_f32_16x16x32_bf16 v[44:47], v[108:111], v[76:79], v[44:47]
    s_waitcnt lgkmcnt(3)
    v_mfma_f32_16x16x32_bf16 v[44:47], v[112:115], v[80:83], v[44:47]
    s_waitcnt lgkmcnt(2)
    v_mfma_f32_16x16x32_bf16 v[44:47], v[116:119], v[84:87], v[44:47]
    s_waitcnt lgkmcnt(1)
    v_mfma_f32_16x16x32_bf16 v[44:47], v[120:123], v[88:91], v[44:47]
    s_waitcnt lgkmcnt(0)
    v_mfma_f32_16x16x32_bf16 v[44:47], v[124:127], v[92:95], v[44:47]
    v_readlane_b32 s56, v16, s54
    s_nop 6
    ds_write_b128 v11, v[44:47]
    v_max3_f32 v60, v60, v44, v45
    v_add_u32 v11, 4096, v11
    v_max3_f32 v60, v60, v46, v47
L_kidle:
    s_add_u32 s60, s60, 16896
    s_cmp_eq_u32 s60, 67584
    s_cselect_b32 s60, 0, s60
    s_add_u32 s53, s53, 1
    s_add_u32 s57, s57, 2
    v_add_u32 v10, s60, v8
    s_cmp_lt_u32 s57, s50
    s_cbranch_scc1 L_kloop
    v_mov_b32 v31, v60
    s_lshl_b32 s68, s30, 8
    v_lshlrev_b32 v32, 2, v1
    v_permlane32_swap_b32 v60, v31
    v_max_f32 v60, v60, v31
    v_mov_b32 v31, v60
    v_add_u32 v32, 151552, v32
    v_add_u32 v33, s68, v32
    v_permlane16_swap_b32 v60, v31
    v_max_f32 v60, v60, v31
    ds_write_b32 v33, v60
    v_add_u32 v10, s60, v9
    v_mov_b32 v11, v12
    s_mov_b32 s57, 0
    s_sub_u32 s1, s50, 30
    s_andn2_b32 s1, s1, 1
    s_cmp_ge_i32 s1, s0
    s_cselect_b32 s1, s1, -1
    s_cmp_eq_u32 s51, 0
    s_cselect_b32 s1, s1, -1
    s_waitcnt lgkmcnt(0)
    s_barrier
    ds_read_b32 v34, v32 offset:0
    ds_read_b32 v35, v32 offset:256
    ds_read_b32 v36, v32 offset:512
    ds_read_b32 v37, v32 offset:768
    ds_read_b128 v[44:47], v11
    ds_read_b128 v[48:51], v11 offset:1024
    s_waitcnt lgkmcnt(2)
    v_max3_f32 v21, v34, v35, v36
    v_max_f32 v21, v21, v37
    v_mul_f32 v30, s62, v21
    v_sub_f32 v56, v22, v30
    v_exp_f32 v56, v56
    v_mov_b32 v22, v30
    v_pk_mul_f32 v[128:129], v[128:129], v[56:57] op_sel_hi:[1,0]
    v_pk_mul_f32 v[130:131], v[130:131], v[56:57] op_sel_hi:[1,0]
    v_pk_mul_f32 v[132:133], v[132:133], v[56:57] op_sel_hi:[1,0]
    v_pk_mul_f32 v[134:135], v[134:135], v[56:57] op_sel_hi:[1,0]
    v_pk_mul_f32 v[136:137], v[136:137], v[56:57] op_sel_hi:[1,0]
    v_pk_mul_f32 v[138:139], v[138:139], v[56:57] op_sel_hi:[1,0]
    v_pk_mul_f32 v[140:141], v[140:141], v[56:57] op_sel_hi:[1,0]
    v_pk_mul_f32 v[142:143], v[142:143], v[56:57] op_sel_hi:[1,0]
    v_mul_f32 v23, v56, v23
    s_waitcnt lgkmcnt(0)
    v_fma_f32 v44, v44, s62, -v22
    v_fma_f32 v45, v45, s62, -v22
    v_fma_f32 v46, v46, s62, -v22
    v_fma_f32 v47, v47, s62, -v22
    v_fma_f32 v48, v48, s62, -v22
    v_fma_f32 v49, v49, s62, -v22
    v_fma_f32 v50, v50, s62, -v22
    v_fma_f32 v51, v51, s62, -v22
    v_exp_f32 v44, v44
    v_exp_f32 v45, v45
    v_exp_f32 v46, v46
    v_exp_f32 v47, v47
    v_exp_f32 v48, v48
    v_exp_f32 v49, v49
    v_exp_f32 v50, v50
    v_exp_f32 v51, v51
    v_cvt_pk_bf16_f32 v148, v44, v45
    v_cvt_pk_bf16_f32 v149, v46, v47
    v_cvt_pk_bf16_f32 v150, v48, v49
    v_cvt_pk_bf16_f32 v151, v50, v51
    v_pk_add_f32 v[44:45], v[44:45], v[46:47]
    v_pk_add_f32 v[48:49], v[48:49], v[50:51]
    v_add_u32 v11, 2048, v11
    v_pk_add_f32 v[44:45], v[44:45], v[48:49]
    v_add_f32 v23, v23, v44
    v_add_f32 v23, v23, v45
    s_mov_b32 s71, 1
    s_cmp_le_u32 s50, 2
    s_cbranch_scc1 L_vlast
    ds_read_b128 v[44:47], v11
    ds_read_b128 v[48:51], v11 offset:1024
    v_mov_b32 v52, v148
    v_mov_b32 v53, v149
    v_mov_b32 v54, v150
    v_mov_b32 v55, v151
    s_waitcnt lgkmcnt(0)
    v_fma_f32 v44, v44, s62, -v22
    v_fma_f32 v45, v45, s62, -v22
    v_fma_f32 v46, v46, s62, -v22
    v_fma_f32 v47, v47, s62, -v22
    v_fma_f32 v48, v48, s62, -v22
    v_fma_f32 v49, v49, s62, -v22
    v_fma_f32 v50, v50, s62, -v22
    v_fma_f32 v51, v51, s62, -v22
    v_exp_f32 v44, v44
    v_exp_f32 v45, v45
    v_exp_f32 v46, v46
    v_exp_f32 v47, v47
    v_exp_f32 v48, v48
    v_exp_f32 v49, v49
    v_exp_f32 v50, v50
    v_exp_f32 v51, v51
    v_cvt_pk_bf16_f32 v148, v44, v45
    v_cvt_pk_bf16_f32 v149, v46, v47
    v_cvt_pk_bf16_f32 v150, v48, v49
    v_cvt_pk_bf16_f32 v151, v50, v51
    v_pk_add_f32 v[44:45], v[44:45], v[46:47]
    v_pk_add_f32 v[48:49], v[48:49], v[50:51]
    v_add_u32 v11, 2048, v11
    v_pk_add_f32 v[44:45], v[44:45], v[48:49]
    v_add_f32 v23, v23, v44
    v_add_f32 v23, v23, v45
    s_cmp_gt_u32 s50, 4
    s_cbranch_scc1 L_vin
    s_branch L_vlast
L_vloop:
    s_barrier
L_vin:
    ds_read_b64_tr_b16 v[96:97], v10 offset:0
    ds_read_b64_tr_b16 v[98:99], v10 offset:8448
    ds_read_b64_tr_b16 v[100:101], v10 offset:32
    ds_read_b64_tr_b16 v[102:103], v10 offset:8480
    ds_read_b64_tr_b16 v[104:105], v10 offset:64
    ds_read_b64_tr_b16 v[106:107], v10 offset:8512
    ds_read_b64_tr_b16 v[108:109], v10 offset:96
    ds_read_b64_tr_b16 v[110:111], v10 offset:8544
    ds_read_b128 v[44:47], v11
    ds_read_b128 v[48:51], v11 offset:1024
    s_cmp_eq_u32 s57, s1
    s_cbranch_scc1 L_pub
L_pubd:
    s_waitcnt lgkmcnt(8)
    v_mfma_f32_16x16x32_bf16 v[128:131], v[96:99], v[52:55], v[128:131]
    s_waitcnt lgkmcnt(6)
    v_mfma_f32_16x16x32_bf16 v[132:135], v[100:103], v[52:55], v[132:135]
    s_waitcnt lgkmcnt(4)
    v_mfma_f32_16x16x32_bf16 v[136:139], v[104:107], v[52:55], v[136:139]
    s_waitcnt lgkmcnt(2)
    v_mfma_f32_16x16x32_bf16 v[140:143], v[108:111], v[52:55], v[140:143]
    s_add_u32 s60, s60, 16896
    s_cmp_eq_u32 s60, 67584
    s_cselect_b32 s60, 0, s60
    s_add_u32 s53, s53, 1
    s_add_u32 s57, s57, 2
    v_add_u32 v10, s60, v9
    v_mov_b32 v52, v148
    v_mov_b32 v53, v149
    v_mov_b32 v54, v150
    v_mov_b32 v55, v151
    s_waitcnt lgkmcnt(0)
    v_fma_f32 v44, v44, s62, -v22
    v_fma_f32 v45, v45, s62, -v22
    v_fma_f32 v46, v46, s62, -v22
    v_fma_f32 v47, v47, s62, -v22
    v_fma_f32 v48, v48, s62, -v22
    v_fma_f32 v49, v49, s62, -v22
    v_fma_f32 v50, v50, s62, -v22
    v_fma_f32 v51, v51, s62, -v22
    v_exp_f32 v44, v44
    v_exp_f32 v45, v45
    v_exp_f32 v46, v46
    v_exp_f32 v47, v47
    v_exp_f32 v48, v48
    v_exp_f32 v49, v49
    v_exp_f32 v50, v50
    v_exp_f32 v51, v51
    v_cvt_pk_bf16_f32 v148, v44, v45
    v_cvt_pk_bf16_f32 v149, v46, v47
    v_cvt_pk_bf16_f32 v150, v48, v49
    v_cvt_pk_bf16_f32 v151, v50, v51
    v_pk_add_f32 v[44:45], v[44:45], v[46:47]
    v_pk_add_f32 v[48:49], v[48:49], v[50:51]
    v_add_u32 v11, 2048, v11
    v_pk_add_f32 v[44:45], v[44:45], v[48:49]
    v_add_f32 v23, v23, v44
    v_add_f32 v23, v23, v45
    s_add_u32 s68, s57, 4
    s_cmp_lt_u32 s68, s50
    s_cbranch_scc1 L_vloop
    s_mov_b32 s71, 0
    s_cmp_lg_u32 s51, 0
    s_cbranch_scc1 L_nostat
L_vlast:
    s_cmp_ge_u32 s29, 4
    s_cbranch_scc1 L_nocount
    global_load_dword v62, v61, s[16:17] sc1
    buffer_load_dword v13, v63, s[84:87], 0 offen sc1
L_nocount:
    v_mov_b32 v36, 149504
    ds_read_b128 v[38:41], v36 offset:16
    v_bfe_u32 v36, v0, 1, 3
    s_waitcnt lgkmcnt(0)
    v_lshrrev_b32 v36, v36, v38
    v_readfirstlane_b32 s63, v38
    v_and_b32 v36, 1, v36
    v_readfirstlane_b32 s77, v39
    v_cmp_eq_u32 s[78:79], 1, v36
    v_readfirstlane_b32 s74, v40
    v_readfirstlane_b32 s3, v41
    s_and_b64 s[78:79], s[78:79], s[26:27]
    v_mov_b32 v28, v23
    s_mov_b32 s68, -2
    s_lshl2_add_u32 s69, s30, s77
    v_permlane32_swap_b32 v23, v28
    v_add_f32 v23, v23, v28
    v_mov_b32 v28, v23
    v_min_u32 v22, s68, v22
    s_cmp_lg_u32 s69, 2
    v_permlane16_swap_b32 v23, v28
    v_add_f32 v23, v23, v28
    v_min_u32 v23, s68, v23
    s_cbranch_scc1 L_nostat
    s_and_b64 exec, s[78:79], 0xffff
    s_bitcmp0_b32 s3, 0
    s_cbranch_scc1 L_recga
    buffer_store_dwordx2 v[22:23], v7, s[84:87], 0 offen offset:1024
    s_branch L_recda
L_recga:
    buffer_store_dwordx2 v[22:23], v7, s[84:87], 0 offen offset:1024 sc1
L_recda:
    s_mov_b64 exec, -1
L_nostat:
    s_cmp_le_u32 s50, 2
    s_cbranch_scc1 L_nobar
    s_cmp_lg_u32 s71, 0
    s_cbranch_scc1 L_nobar2
    s_barrier
L_nobar2:
    ds_read_b64_tr_b16 v[96:97], v10 offset:0
    ds_read_b64_tr_b16 v[98:99], v10 offset:8448
    ds_read_b64_tr_b16 v[100:101], v10 offset:32
    ds_read_b64_tr_b16 v[102:103], v10 offset:8480
    ds_read_b64_tr_b16 v[104:105], v10 offset:64
    ds_read_b64_tr_b16 v[106:107], v10 offset:8512
    ds_read_b64_tr_b16 v[108:109], v10 offset:96
    ds_read_b64_tr_b16 v[110:111], v10 offset:8544
    s_add_u32 s60, s60, 16896
    s_cmp_eq_u32 s60, 67584
    s_cselect_b32 s60, 0, s60
    s_add_u32 s53, s53, 1
    s_add_u32 s57, s57, 2
    v_add_u32 v10, s60, v9
    s_waitcnt lgkmcnt(6)
    v_mfma_f32_16x16x32_bf16 v[128:131], v[96:99], v[52:55], v[128:131]
    s_waitcnt lgkmcnt(4)
    v_mfma_f32_16x16x32_bf16 v[132:135], v[100:103], v[52:55], v[132:135]
    s_waitcnt lgkmcnt(2)
    v_mfma_f32_16x16x32_bf16 v[136:139], v[104:107], v[52:55], v[136:139]
    s_waitcnt lgkmcnt(0)
    v_mfma_f32_16x16x32_bf16 v[140:143], v[108:111], v[52:55], v[140:143]
    s_barrier
L_nobar:
    ds_read_b64_tr_b16 v[96:97], v10 offset:0
    ds_read_b64_tr_b16 v[98:99], v10 offset:8448
    ds_read_b64_tr_b16 v[100:101], v10 offset:32
    ds_read_b64_tr_b16 v[102:103], v10 offset:8480
    ds_read_b64_tr_b16 v[104:105], v10 offset:64
    ds_read_b64_tr_b16 v[106:107], v10 offset:8512
    ds_read_b64_tr_b16 v[108:109], v10 offset:96
    ds_read_b64_tr_b16 v[110:111], v10 offset:8544
    s_cmp_lg_u32 s51, 0
    s_waitcnt lgkmcnt(6)
    v_mfma_f32_16x16x32_bf16 v[128:131], v[96:99], v[148:151], v[128:131]
    s_waitcnt lgkmcnt(4)
    v_mfma_f32_16x16x32_bf16 v[132:135], v[100:103], v[148:151], v[132:135]
    s_waitcnt lgkmcnt(2)
    v_mfma_f32_16x16x32_bf16 v[136:139], v[104:107], v[148:151], v[136:139]
    s_waitcnt lgkmcnt(0)
    v_mfma_f32_16x16x32_bf16 v[140:143], v[108:111], v[148:151], v[140:143]
    s_cbranch_scc1 L_more
    s_mov_b64 exec, s[78:79]
    s_bitcmp0_b32 s3, 0
    s_cbranch_scc1 L_outg
    v_cvt_pk_bf16_f32 v112, v128, v129
    v_cvt_pk_bf16_f32 v113, v130, v131
    v_cvt_pk_bf16_f32 v114, v132, v133
    v_cvt_pk_bf16_f32 v115, v134, v135
    v_min_u32 v112, s68, v112
    v_min_u32 v113, s68, v113
    v_min_u32 v114, s68, v114
    v_min_u32 v115, s68, v115
    buffer_store_dwordx4 v[112:115], v6, s[84:87], 0 offen offset:0
    v_cvt_pk_bf16_f32 v116, v136, v137
    v_cvt_pk_bf16_f32 v117, v138, v139
    v_cvt_pk_bf16_f32 v118, v140, v141
    v_cvt_pk_bf16_f32 v119, v142, v143
    v_min_u32 v116, s68, v116
    v_min_u32 v117, s68, v117
    v_min_u32 v118, s68, v118
    v_min_u32 v119, s68, v119
    buffer_store_dwordx4 v[116:119], v6, s[84:87], 0 offen offset:128
L_outd:
    s_mov_b64 exec, -1
    s_cmp_eq_u32 s77, 2
    s_cbranch_scc1 L_poll
    s_waitcnt vmcnt(0)
    s_barrier
    s_cmp_lg_u32 s30, 0
    s_cbranch_scc1 L_poll
    s_and_b64 exec, s[78:79], 0xffff
    s_bitcmp0_b32 s3, 0
    s_cbranch_scc1 L_recgb
    buffer_store_dwordx2 v[22:23], v7, s[84:87], 0 offen offset:1024
    s_branch L_recdb
L_recgb:
    buffer_store_dwordx2 v[22:23], v7, s[84:87], 0 offen offset:1024 sc1
L_recdb:
    s_mov_b64 exec, -1
    s_cmp_eq_u32 s77, 1
    s_cbranch_scc1 L_poll
    s_waitcnt vmcnt(0)
    s_lshl4_add_u32 s68, s28, 128
    v_lshrrev_b32 v28, 1, v1
    v_lshl_add_u32 v28, v28, 2, s68
    v_and_b32 v29, 1, v1
    v_lshlrev_b32 v29, 4, v29
    v_lshlrev_b32 v29, v29, 1
    s_mov_b32 exec_lo, s63
    s_mov_b32 exec_hi, 0
    global_atomic_add v28, v29, s[16:17]
    s_mov_b64 exec, -1
L_poll:
    s_mov_b32 s54, 0
    s_cmp_ge_u32 s29, 4
    s_cbranch_scc1 L_fin
    s_lshr_b32 s56, s30, 1
    s_lshl1_add_u32 s56, s29, s56
    s_sub_u32 s56, 7, s56
    s_lshl_b32 s68, s56, 2
    s_add_u32 s69, s68, 149536
    v_mov_b32 v34, s69
    ds_read_b32 v36, v34
    v_and_b32 v34, 127, v59
    v_lshlrev_b32 v30, 3, v34
    v_bfe_u32 v35, v0, 1, 1
    v_lshlrev_b32 v31, 4, v35
    v_lshrrev_b32 v34, 4, v34
    v_lshlrev_b32 v34, 6, v34
    v_lshl_add_u32 v32, v35, 9, v34
    v_and_b32 v35, 1, v0
    v_lshl_add_u32 v32, v35, 5, v32
    v_bfe_u32 v35, v0, 2, 2
    v_lshl_add_u32 v32, v35, 3, v32
    s_lshl_b32 s68, s28, 10
    s_lshl_b32 s69, s56, 13
    s_add_u32 s68, s68, s69
    v_add_u32 v32, s68, v32
    s_mul_i32 s70, s28, 1152
    s_mul_i32 s69, s56, 294912
    s_add_u32 s70, s70, s69
    s_waitcnt lgkmcnt(0)
    v_readfirstlane_b32 s53, v36
    v_mov_b32 v44, 0
    v_mov_b32 v45, 0
    v_mov_b32 v46, 0
    v_mov_b32 v47, 0
    v_mov_b32 v48, 0xff000000
    v_mov_b32 v49, 0
    s_mov_b32 s57, s74
    s_or_b32 s69, s57, s53
    s_cmp_eq_u32 s56, 7
    s_cselect_b32 s57, s53, s57
    s_cselect_b32 s53, s74, s53
    s_bitcmp1_b32 s3, 0
    s_cselect_b32 s64, s69, 0
    s_mov_b32 s65, s69
    s_bcnt1_i32_b32 s69, s69
    s_waitcnt vmcnt(0)
L_cwait:
    v_cmp_ne_u32 vcc, 0, v13
    v_readfirstlane_b32 s68, v62
    s_add_u32 s54, s54, 1
    s_lshl_b32 s71, s56, 4
    s_lshr_b32 s68, s68, s71
    s_and_b32 s68, s68, 0xffff
    s_and_b32 s71, vcc_lo, s64
    s_bcnt1_i32_b32 s71, s71
    s_add_u32 s68, s68, s71
    s_cmp_ge_u32 s68, s69
    s_cbranch_scc1 L_phase
    s_cmp_ge_u32 s54, 4194304
    s_cbranch_scc1 L_phase
    s_sleep 16
    s_lshl_b32 s68, s28, 2
    v_mov_b32 v34, s68
    global_load_dword v34, v34, s[16:17] sc1
    s_waitcnt vmcnt(0)
    global_load_dword v62, v61, s[16:17] sc1
    buffer_load_dword v13, v63, s[84:87], 0 offen sc1
    v_readfirstlane_b32 s68, v34
    s_and_b32 s71, s68, 15
    s_mul_i32 s71, s71, 0x1111
    s_cmp_eq_u32 s68, s71
    s_cselect_b32 s64, s65, 0
    s_bitcmp1_b32 s68, 3
    s_cselect_b32 s64, s64, 0
    s_waitcnt vmcnt(0)
    s_branch L_cwait
L_phase:
    s_cmp_eq_u32 s57, 0
    s_cselect_b32 s57, s53, s57
    s_cselect_b32 s53, 0, s53
L_batch:
    s_bcnt1_i32_b32 s61, s57
    s_flbit_i32_b32 s68, s57
    s_sub_u32 s68, 31, s68
    s_bitset0_b32 s57, s68
    s_mul_i32 s68, s68, 9216
    s_add_u32 s32, s68, s70
    s_flbit_i32_b32 s68, s57
    s_sub_u32 s68, 31, s68
    s_bitset0_b32 s57, s68
    s_mul_i32 s68, s68, 9216
    s_add_u32 s33, s68, s70
    s_cmp_gt_u32 s61, 1
    s_cselect_b32 s33, s33, s32
    s_flbit_i32_b32 s68, s57
    s_sub_u32 s68, 31, s68
    s_bitset0_b32 s57, s68
    s_mul_i32 s68, s68, 9216
    s_add_u32 s34, s68, s70
    s_cmp_gt_u32 s61, 2
    s_cselect_b32 s34, s34, s32
    s_flbit_i32_b32 s68, s57
    s_sub_u32 s68, 31, s68
    s_bitset0_b32 s57, s68
    s_mul_i32 s68, s68, 9216
    s_add_u32 s35, s68, s70
    s_cmp_gt_u32 s61, 3
    s_cselect_b32 s35, s35, s32
    s_flbit_i32_b32 s68, s57
    s_sub_u32 s68, 31, s68
    s_bitset0_b32 s57, s68
    s_mul_i32 s68, s68, 9216
    s_add_u32 s36, s68, s70
    s_cmp_gt_u32 s61, 4
    s_cselect_b32 s36, s36, s32
    s_flbit_i32_b32 s68, s57
    s_sub_u32 s68, 31, s68
    s_bitset0_b32 s57, s68
    s_mul_i32 s68, s68, 9216
    s_add_u32 s37, s68, s70
    s_cmp_gt_u32 s61, 5
    s_cselect_b32 s37, s37, s32
L_hwait:
    buffer_load_dwordx2 v[76:77], v31, s[84:87], s32 offen offset:1024 sc1
    buffer_load_dwordx2 v[78:79], v31, s[84:87], s33 offen offset:1024 sc1
    buffer_load_dwordx2 v[80:81], v31, s[84:87], s34 offen offset:1024 sc1
    buffer_load_dwordx2 v[82:83], v31, s[84:87], s35 offen offset:1024 sc1
    buffer_load_dwordx2 v[84:85], v31, s[84:87], s36 offen offset:1024 sc1
    buffer_load_dwordx2 v[86:87], v31, s[84:87], s37 offen offset:1024 sc1
    s_add_u32 s54, s54, 1
    s_cmp_ge_u32 s54, 4194304
    s_waitcnt vmcnt(0)
    v_max_u32 v34, v76, v79
    v_max_u32 v35, v77, v80
    v_max_u32 v36, v78, v81
    v_max3_u32 v34, v34, v82, v85
    v_max3_u32 v35, v35, v83, v86
    v_max3_u32 v36, v36, v84, v87
    v_max3_u32 v34, v34, v35, v36
    v_cmp_eq_u32 vcc, -1, v34
    s_cbranch_scc1 L_sweep0
    s_cbranch_vccnz L_hwait
L_sweep0:
    buffer_load_dwordx2 v[64:65], v30, s[84:87], s32 offen sc1
    buffer_load_dwordx2 v[66:67], v30, s[84:87], s33 offen sc1
    buffer_load_dwordx2 v[68:69], v30, s[84:87], s34 offen sc1
    buffer_load_dwordx2 v[70:71], v30, s[84:87], s35 offen sc1
    buffer_load_dwordx2 v[72:73], v30, s[84:87], s36 offen sc1
    buffer_load_dwordx2 v[74:75], v30, s[84:87], s37 offen sc1
    v_mov_b32 v36, v48
    v_max3_f32 v36, v36, v76, v78
    v_max3_f32 v36, v36, v80, v82
    v_max3_f32 v36, v36, v84, v86
    v_sub_f32 v48, v48, v36
    v_sub_f32 v76, v76, v36
    v_sub_f32 v78, v78, v36
    v_sub_f32 v80, v80, v36
    v_sub_f32 v82, v82, v36
    v_sub_f32 v84, v84, v36
    v_sub_f32 v86, v86, v36
    v_exp_f32 v48, v48
    v_exp_f32 v76, v76
    v_exp_f32 v78, v78
    v_exp_f32 v80, v80
    v_exp_f32 v82, v82
    v_exp_f32 v84, v84
    v_exp_f32 v86, v86
    v_mul_f32 v49, v48, v49
    v_mul_f32 v44, v48, v44
    v_mul_f32 v45, v48, v45
    v_mul_f32 v46, v48, v46
    v_mul_f32 v47, v48, v47
    v_mov_b32 v48, v36
    v_fmac_f32 v49, v76, v77
    s_cmp_gt_u32 s61, 1
    s_cselect_b32 s68, -1, 0
    v_and_b32 v78, s68, v78
    v_fmac_f32 v49, v78, v79
    s_cmp_gt_u32 s61, 2
    s_cselect_b32 s68, -1, 0
    v_and_b32 v80, s68, v80
    v_fmac_f32 v49, v80, v81
    s_cmp_gt_u32 s61, 3
    s_cselect_b32 s68, -1, 0
    v_and_b32 v82, s68, v82
    v_fmac_f32 v49, v82, v83
    s_cmp_gt_u32 s61, 4
    s_cselect_b32 s68, -1, 0
    v_and_b32 v84, s68, v84
    v_fmac_f32 v49, v84, v85
    s_cmp_gt_u32 s61, 5
    s_cselect_b32 s68, -1, 0
    v_and_b32 v86, s68, v86
    v_fmac_f32 v49, v86, v87
    v_rcp_f32 v37, v49
    s_branch L_check
L_again:
    buffer_load_dwordx2 v[64:65], v30, s[84:87], s32 offen sc1
    buffer_load_dwordx2 v[66:67], v30, s[84:87], s33 offen sc1
    buffer_load_dwordx2 v[68:69], v30, s[84:87], s34 offen sc1
    buffer_load_dwordx2 v[70:71], v30, s[84:87], s35 offen sc1
    buffer_load_dwordx2 v[72:73], v30, s[84:87], s36 offen sc1
    buffer_load_dwordx2 v[74:75], v30, s[84:87], s37 offen sc1
L_check:
    s_add_u32 s54, s54, 1
    s_cmp_ge_u32 s54, 4194304
    s_waitcnt vmcnt(0)
    v_max_u32 v34, v64, v67
    v_max_u32 v35, v65, v68
    v_max_u32 v36, v66, v69
    v_max3_u32 v34, v34, v70, v73
    v_max3_u32 v35, v35, v71, v74
    v_max3_u32 v36, v36, v72, v75
    v_max3_u32 v34, v34, v35, v36
    v_cmp_eq_u32 vcc, -1, v34
    s_cbranch_scc1 L_have
    s_cbranch_vccnz L_again
L_have:
    v_lshlrev_b32 v38, 16, v64
    v_and_b32 v64, 0xffff0000, v64
    v_lshlrev_b32 v39, 16, v65
    v_and_b32 v65, 0xffff0000, v65
    v_pk_fma_f32 v[44:45], v[38:39], v[76:77], v[44:45] op_sel_hi:[1,0,1]
    v_pk_fma_f32 v[46:47], v[64:65], v[76:77], v[46:47] op_sel_hi:[1,0,1]
    s_cmp_le_u32 s61, 4
    v_lshlrev_b32 v40, 16, v66
    v_and_b32 v66, 0xffff0000, v66
    v_lshlrev_b32 v41, 16, v67
    v_and_b32 v67, 0xffff0000, v67
    v_pk_fma_f32 v[44:45], v[40:41], v[78:79], v[44:45] op_sel_hi:[1,0,1]
    v_pk_fma_f32 v[46:47], v[66:67], v[78:79], v[46:47] op_sel_hi:[1,0,1]
    v_lshlrev_b32 v38, 16, v68
    v_and_b32 v68, 0xffff0000, v68
    v_lshlrev_b32 v39, 16, v69
    v_and_b32 v69, 0xffff0000, v69
    v_pk_fma_f32 v[44:45], v[38:39], v[80:81], v[44:45] op_sel_hi:[1,0,1]
    v_pk_fma_f32 v[46:47], v[68:69], v[80:81], v[46:47] op_sel_hi:[1,0,1]
    v_lshlrev_b32 v40, 16, v70
    v_and_b32 v70, 0xffff0000, v70
    v_lshlrev_b32 v41, 16, v71
    v_and_b32 v71, 0xffff0000, v71
    v_pk_fma_f32 v[44:45], v[40:41], v[82:83], v[44:45] op_sel_hi:[1,0,1]
    v_pk_fma_f32 v[46:47], v[70:71], v[82:83], v[46:47] op_sel_hi:[1,0,1]
    s_cbranch_scc1 L_summed
    v_lshlrev_b32 v38, 16, v72
    v_and_b32 v72, 0xffff0000, v72
    v_lshlrev_b32 v39, 16, v73
    v_and_b32 v73, 0xffff0000, v73
    v_pk_fma_f32 v[44:45], v[38:39], v[84:85], v[44:45] op_sel_hi:[1,0,1]
    v_pk_fma_f32 v[46:47], v[72:73], v[84:85], v[46:47] op_sel_hi:[1,0,1]
    v_lshlrev_b32 v40, 16, v74
    v_and_b32 v74, 0xffff0000, v74
    v_lshlrev_b32 v41, 16, v75
    v_and_b32 v75, 0xffff0000, v75
    v_pk_fma_f32 v[44:45], v[40:41], v[86:87], v[44:45] op_sel_hi:[1,0,1]
    v_pk_fma_f32 v[46:47], v[74:75], v[86:87], v[46:47] op_sel_hi:[1,0,1]

L_summed:
    v_pk_mul_f32 v[38:39], v[44:45], v[36:37] op_sel:[0,1] op_sel_hi:[1,1]
    v_pk_mul_f32 v[40:41], v[46:47], v[36:37] op_sel:[0,1] op_sel_hi:[1,1]
    s_or_b32 s68, s57, s53
    v_cvt_pk_bf16_f32 v42, v38, v40
    v_cvt_pk_bf16_f32 v43, v39, v41
    s_cbranch_scc1 L_phase
    global_store_dwordx2 v32, v[42:43], s[14:15]
L_fin:
L_end:
    s_endpgm
L_pub:
    v_mov_b32 v36, 149504
    ds_read_b128 v[38:41], v36 offset:16
    v_bfe_u32 v36, v0, 1, 3
    s_waitcnt lgkmcnt(0)
    v_lshrrev_b32 v36, v36, v38
    v_readfirstlane_b32 s63, v38
    v_and_b32 v36, 1, v36
    v_readfirstlane_b32 s77, v39
    v_cmp_eq_u32 s[78:79], 1, v36
    v_readfirstlane_b32 s74, v40
    v_readfirstlane_b32 s3, v41
    v_mov_b32 v29, v23
    v_mov_b32 v30, v23
    s_cmp_lg_u32 s77, 2
    s_cbranch_scc1 L_pubd
    s_bitcmp1_b32 s74, s29
    s_cbranch_scc1 L_pubd
    s_bitcmp0_b32 s3, 1
    s_cbranch_scc1 L_pubd
    s_cmp_le_u32 s63, 0x80
    s_cbranch_scc1 L_pubd
    s_mov_b32 s68, -2
    v_permlane32_swap_b32 v29, v30
    v_add_f32 v29, v29, v30
    v_mov_b32 v30, v29
    s_mov_b32 s78, 0xc000c000
    s_mov_b32 s79, 0xc000c000
    v_permlane16_swap_b32 v29, v30
    v_add_f32 v29, v29, v30
    v_min_u32 v28, s68, v22
    v_min_u32 v29, s68, v29
    s_not_b64 s[26:27], s[78:79]
    s_cmp_lg_u32 s30, 0
    s_cbranch_scc1 L_pubo
    s_and_b64 exec, s[78:79], 0xffff
    s_bitcmp0_b32 s3, 0
    s_cbranch_scc1 L_recgp
    buffer_store_dwordx2 v[28:29], v7, s[84:87], 0 offen offset:1024
    s_branch L_recdp
L_recgp:
    buffer_store_dwordx2 v[28:29], v7, s[84:87], 0 offen offset:1024 sc1
L_recdp:
    s_mov_b64 exec, -1
L_pubo:
    s_mov_b64 exec, s[78:79]
    s_bitcmp0_b32 s3, 0
    s_cbranch_scc1 L_pubg
    v_cvt_pk_bf16_f32 v112, v128, v129
    v_cvt_pk_bf16_f32 v113, v130, v131
    v_cvt_pk_bf16_f32 v114, v132, v133
    v_cvt_pk_bf16_f32 v115, v134, v135
    v_min_u32 v112, s68, v112
    v_min_u32 v113, s68, v113
    v_min_u32 v114, s68, v114
    v_min_u32 v115, s68, v115
    buffer_store_dwordx4 v[112:115], v6, s[84:87], 0 offen offset:0
    v_cvt_pk_bf16_f32 v116, v136, v137
    v_cvt_pk_bf16_f32 v117, v138, v139
    v_cvt_pk_bf16_f32 v118, v140, v141
    v_cvt_pk_bf16_f32 v119, v142, v143
    v_min_u32 v116, s68, v116
    v_min_u32 v117, s68, v117
    v_min_u32 v118, s68, v118
    v_min_u32 v119, s68, v119
    buffer_store_dwordx4 v[116:119], v6, s[84:87], 0 offen offset:128
    s_branch L_pube
L_pubg:
    v_cvt_pk_bf16_f32 v112, v128, v129
    v_cvt_pk_bf16_f32 v113, v130, v131
    v_cvt_pk_bf16_f32 v114, v132, v133
    v_cvt_pk_bf16_f32 v115, v134, v135
    v_min_u32 v112, s68, v112
    v_min_u32 v113, s68, v113
    v_min_u32 v114, s68, v114
    v_min_u32 v115, s68, v115
    buffer_store_dwordx4 v[112:115], v6, s[84:87], 0 offen offset:0 sc1
    v_cvt_pk_bf16_f32 v116, v136, v137
    v_cvt_pk_bf16_f32 v117, v138, v139
    v_cvt_pk_bf16_f32 v118, v140, v141
    v_cvt_pk_bf16_f32 v119, v142, v143
    v_min_u32 v116, s68, v116
    v_min_u32 v117, s68, v117
    v_min_u32 v118, s68, v118
    v_min_u32 v119, s68, v119
    buffer_store_dwordx4 v[116:119], v6, s[84:87], 0 offen offset:128 sc1
L_pube:
    s_mov_b64 exec, -1
    s_nop 1
    s_branch L_pubd
L_outg:
    v_cvt_pk_bf16_f32 v112, v128, v129
    v_cvt_pk_bf16_f32 v113, v130, v131
    v_cvt_pk_bf16_f32 v114, v132, v133
    v_cvt_pk_bf16_f32 v115, v134, v135
    v_min_u32 v112, s68, v112
    v_min_u32 v113, s68, v113
    v_min_u32 v114, s68, v114
    v_min_u32 v115, s68, v115
    buffer_store_dwordx4 v[112:115], v6, s[84:87], 0 offen offset:0 sc1
    v_cvt_pk_bf16_f32 v116, v136, v137
    v_cvt_pk_bf16_f32 v117, v138, v139
    v_cvt_pk_bf16_f32 v118, v140, v141
    v_cvt_pk_bf16_f32 v119, v142, v143
    v_min_u32 v116, s68, v116
    v_min_u32 v117, s68, v117
    v_min_u32 v118, s68, v118
    v_min_u32 v119, s68, v119
    buffer_store_dwordx4 v[116:119], v6, s[84:87], 0 offen offset:128 sc1
    s_branch L_outd
L_bias:
    s_and_b32 s70, s56, 0xffff
    s_lshr_b32 s68, s56, 16
    s_sub_u32 s68, s68, 2
    s_and_b32 s69, s68, 14
    v_readlane_b32 s48, v19, s69
    s_lshl_b64 s[58:59], s[72:73], s69
    s_cmp_eq_u32 s68, -1
    s_cselect_b64 s[58:59], -1, s[58:59]
    s_cselect_b32 s48, s49, s48
    v_subrev_u32 v28, s70, v19
    v_cndmask_b32 v28, 0, v28, s[58:59]
    s_sub_u32 s55, s56, s70
    s_sub_u32 s48, s48, 16
    s_cmp_le_i32 s70, s48
    s_cselect_b32 s55, s55, 0x80000000
    s_cselect_b32 s48, s48, 0
    v_cmp_lt_i32 s[64:65], 0, v28
    v_cmp_lt_i32 s[66:67], 1, v28
    v_cmp_lt_i32 s[58:59], 2, v28
    v_cmp_lt_i32 vcc, 3, v28
    v_cndmask_b32 v24, v58, 0, s[64:65]
    v_cndmask_b32 v25, v58, 0, s[66:67]
    v_cndmask_b32 v26, v58, 0, s[58:59]
    v_cndmask_b32 v27, v58, 0, vcc
    s_branch L_biased
L_more:
    s_add_u32 s60, s60, 16896
    s_cmp_eq_u32 s60, 67584
    s_cselect_b32 s60, 0, s60
    s_add_u32 s53, s53, 1
    s_add_u32 s57, s57, 2
    v_mov_b32 v16, v17
    v_mov_b32 v17, v18
    s_min_u32 s50, s51, 64
    s_sub_u32 s51, s51, s50
L_chunk:
    s_mov_b32 s54, s30
    s_mov_b32 s57, 0
    s_lshl_b32 s68, s30, 10
    v_add_u32 v11, s68, v12
    v_mov_b32 v60, v21
    v_add_u32 v10, s60, v8
    v_readlane_b32 s56, v16, s54
    s_branch L_kloop
L_cmail:
    v_mov_b32 v36, 149504
    v_lshl_add_u32 v37, v1, 2, v36
    ds_read_b128 v[38:41], v36
    ds_read_b32 v16, v37 offset:832
    ds_read_b32 v17, v37 offset:1088
    ds_read_b32 v18, v37 offset:1344
    s_waitcnt lgkmcnt(0)
    v_readfirstlane_b32 s52, v38
    v_readfirstlane_b32 s69, v39
    v_readfirstlane_b32 s0, v41
    s_mov_b32 s76, -1
    s_min_u32 s50, s52, 64
    s_sub_u32 s51, s52, s50
    s_cmp_eq_u32 s69, 0
    s_cbranch_scc1 L_kin
    s_barrier
    s_mov_b32 s53, 0
    s_mov_b32 s60, 0
    s_mov_b32 s48, 0
    s_mov_b32 s55, 0x80000000
    s_cmp_lg_u32 s52, 0
    s_cbranch_scc1 L_chunk
    v_mov_b32 v36, 149504
    ds_read_b128 v[38:41], v36 offset:16
    v_bfe_u32 v36, v0, 1, 3
    s_waitcnt lgkmcnt(0)
    v_lshrrev_b32 v36, v36, v38
    v_readfirstlane_b32 s63, v38
    v_and_b32 v36, 1, v36
    v_readfirstlane_b32 s77, v39
    v_cmp_eq_u32 s[78:79], 1, v36
    v_readfirstlane_b32 s74, v40
    v_readfirstlane_b32 s3, v41
    s_branch L_poll
L_helper:
    s_getreg_b32 s69, hwreg(HW_REG_XCC_ID, 0, 4)
    s_lshl_b32 s68, s28, 2
    v_mov_b32 v4, s68
    s_cmp_lg_u32 s29, 0
    s_cbranch_scc1 L_hnoann
    buffer_load_dword v145, v63, s[84:87], 0 offen sc1
L_hnoann:
    s_and_b32 s68, s69, 7
    s_lshl_b32 s68, s68, 8
    s_add_u32 s68, s68, 8388608
    v_and_b32 v21, 31, v1
    v_lshl_add_u32 v21, v21, 2, s68
    buffer_load_dword v20, v21, s[84:87], 0 offen nt
    s_waitcnt lgkmcnt(0)
    v_mov_b32 v19, s20
    s_lshl_b64 exec, s[72:73], 2
    v_mov_b32 v19, s21
    s_lshl_b64 exec, s[72:73], 4
    v_mov_b32 v19, s22
    s_lshl_b64 exec, s[72:73], 6
    v_mov_b32 v19, s23
    s_lshl_b64 exec, s[72:73], 8
    v_mov_b32 v19, s24
    s_lshl_b64 exec, s[72:73], 10
    v_mov_b32 v19, s25
    s_lshl_b64 exec, s[72:73], 12
    v_mov_b32 v19, s26
    s_lshl_b64 exec, s[72:73], 14
    v_mov_b32 v19, s27
    s_mov_b64 exec, -1
    s_add_u32 s14, s18, 8390656
    s_addc_u32 s15, s19, 0
    s_cmp_lg_u32 s29, 16
    s_cbranch_scc1 L_hnosnap
    s_load_dword s20, s[14:15], 0 glc
    s_load_dword s21, s[14:15], 256 glc
    s_load_dword s22, s[14:15], 512 glc
    s_load_dword s23, s[14:15], 768 glc
    s_load_dword s24, s[14:15], 1024 glc
    s_load_dword s25, s[14:15], 1280 glc
    s_load_dword s26, s[14:15], 1536 glc
    s_load_dword s27, s[14:15], 1792 glc
L_hnosnap:
    s_mov_b32 s80, s10
    s_and_b32 s81, s11, 0xffff
    s_mov_b32 s82, 16384
    s_mov_b32 s83, 0x20000
    s_mov_b32 s10, 133120
    s_mov_b32 s11, s69
    v_lshlrev_b32 v33, 4, v1
    s_mov_b32 s62, s42
    v_subrev_u32 v12, s38, v1
    v_or_b32 v13, 7, v12
    v_cmp_gt_u32 vcc, s41, v13
    v_bfe_u32 v13, v12, 1, 2
    v_and_b32 v14, 1, v12
    v_lshl_or_b32 v13, v14, 2, v13
    v_and_or_b32 v13, v12, -8, v13
    v_cndmask_b32 v12, v12, v13, vcc
    v_add_u32 v14, s38, v12
    v_cmp_le_u32 vcc, s40, v14
    v_add_u32 v12, s37, v14
    v_subrev_u32 v13, s41, v12
    v_cndmask_b32 v12, v12, v13, vcc
    v_cmp_gt_u32 vcc, s38, v1
    v_add_u32 v13, s36, v1
    s_nop 0
    v_cndmask_b32 v12, v12, v13, vcc
    v_cmp_gt_u32 vcc, 4, v1
    v_lshl_add_u32 v13, v1, 5, s39
    s_nop 0
    v_cndmask_b32 v12, v12, v13, vcc
    v_mov_b32 v13, 0
    v_add_u32 v14, 256, v12
    v_cmpx_le_i32 vcc, 229, v12
    v_mov_b32 v13, -283
    v_cmpx_le_i32 vcc, 431, v12
    v_mov_b32 v13, -593
    v_cmpx_le_i32 vcc, 606, v12
    v_mov_b32 v13, -930
    v_cmpx_le_i32 vcc, 754, v12
    v_mov_b32 v13, -1294
    v_cmpx_le_i32 vcc, 1003, v12
    v_mov_b32 v13, -1557
    v_cmpx_le_i32 vcc, 1225, v12
    v_mov_b32 v13, -1847
    v_cmpx_le_i32 vcc, 1420, v12
    v_mov_b32 v13, -2164
    s_mov_b64 exec, -1
    v_sub_u32 v13, v14, v13
    v_and_b32 v13, 4095, v13
    v_cmp_le_i32 vcc, 0, v12
    v_lshrrev_b32 v14, 9, v13
    v_and_b32 v13, 511, v13
    v_lshl_add_u32 v8, v14, 8, v13
    v_lshl_add_u32 v14, v14, 1, 2
    v_and_b32 v14, 14, v14
    v_cndmask_b32 v14, 1, v14, vcc
    v_lshlrev_b32 v13, 4, v13
    v_lshl_add_u32 v9, v14, 16, v13
    v_lshlrev_b32 v8, 16, v8
    s_barrier
    s_mov_b32 m0, 133120
    s_mov_b32 s68, 0
    buffer_load_dwordx4 v33, s[80:83], s68 offen offset:0 lds
    buffer_load_dwordx4 v33, s[80:83], s68 offen offset:1024 lds
    buffer_load_dwordx4 v33, s[80:83], s68 offen offset:2048 lds
    buffer_load_dwordx4 v33, s[80:83], s68 offen offset:3072 lds
    s_mov_b32 m0, 137216
    s_mov_b32 s68, 4096
    buffer_load_dwordx4 v33, s[80:83], s68 offen offset:0 lds
    buffer_load_dwordx4 v33, s[80:83], s68 offen offset:1024 lds
    buffer_load_dwordx4 v33, s[80:83], s68 offen offset:2048 lds
    buffer_load_dwordx4 v33, s[80:83], s68 offen offset:3072 lds
    s_mov_b32 m0, 141312
    s_mov_b32 s68, 8192
    buffer_load_dwordx4 v33, s[80:83], s68 offen offset:0 lds
    buffer_load_dwordx4 v33, s[80:83], s68 offen offset:1024 lds
    buffer_load_dwordx4 v33, s[80:83], s68 offen offset:2048 lds
    buffer_load_dwordx4 v33, s[80:83], s68 offen offset:3072 lds
    s_mov_b32 m0, 145408
    s_mov_b32 s68, 12288
    buffer_load_dwordx4 v33, s[80:83], s68 offen offset:0 lds
    buffer_load_dwordx4 v33, s[80:83], s68 offen offset:1024 lds
    buffer_load_dwordx4 v33, s[80:83], s68 offen offset:2048 lds
    buffer_load_dwordx4 v33, s[80:83], s68 offen offset:3072 lds
    s_barrier
    v_mov_b32 v36, 8192
    v_cmp_lt_i32 vcc, 0, v19
    v_min_i32 v10, v19, v36
    v_add_u32 v33, s10, v33
    v_cndmask_b32 v10, v36, v10, vcc
    v_add_u32 v10, 15, v10
    v_lshrrev_b32 v10, 4, v10
    s_nop 1
    v_max_u32_dpp v31, v10, v10 row_ror:2 row_mask:0xf bank_mask:0xf
    s_nop 1
    v_max_u32_dpp v31, v31, v31 row_ror:4 row_mask:0xf bank_mask:0xf
    s_nop 1
    v_max_u32_dpp v31, v31, v31 row_ror:8 row_mask:0xf bank_mask:0xf
    s_barrier
    v_readfirstlane_b32 s71, v31
    s_waitcnt vmcnt(0) lgkmcnt(0)
    s_cmp_lg_u32 s29, 0
    s_cbranch_scc1 L_hnoclr
    v_mov_b32 v5, 0
    buffer_store_dword v5, v63, s[84:87], 0 offen
L_hnoclr:
    ds_read_b128 v[64:67], v33 offset:0
    ds_read_b128 v[68:71], v33 offset:2048
    ds_read_b128 v[72:75], v33 offset:4096
    ds_read_b128 v[76:79], v33 offset:6144
    ds_read_b128 v[80:83], v33 offset:8192
    ds_read_b128 v[84:87], v33 offset:10240
    ds_read_b128 v[88:91], v33 offset:12288
    ds_read_b128 v[92:95], v33 offset:14336
    ds_read_b128 v[96:99], v33 offset:1024
    ds_read_b128 v[100:103], v33 offset:3072
    ds_read_b128 v[104:107], v33 offset:5120
    ds_read_b128 v[108:111], v33 offset:7168
    ds_read_b128 v[112:115], v33 offset:9216
    ds_read_b128 v[116:119], v33 offset:11264
    ds_read_b128 v[120:123], v33 offset:13312
    ds_read_b128 v[124:127], v33 offset:15360
    s_waitcnt lgkmcnt(8)
    v_cmpx_eq_u64 vcc, v[64:65], v[68:69]
    v_cmpx_eq_u64 vcc, v[66:67], v[70:71]
    v_cmpx_eq_u64 vcc, v[64:65], v[72:73]
    v_cmpx_eq_u64 vcc, v[66:67], v[74:75]
    v_cmpx_eq_u64 vcc, v[64:65], v[76:77]
    v_cmpx_eq_u64 vcc, v[66:67], v[78:79]
    v_cmpx_eq_u64 vcc, v[64:65], v[80:81]
    v_cmpx_eq_u64 vcc, v[66:67], v[82:83]
    v_cmpx_eq_u64 vcc, v[64:65], v[84:85]
    v_cmpx_eq_u64 vcc, v[66:67], v[86:87]
    v_cmpx_eq_u64 vcc, v[64:65], v[88:89]
    v_cmpx_eq_u64 vcc, v[66:67], v[90:91]
    v_cmpx_eq_u64 vcc, v[64:65], v[92:93]
    v_cmpx_eq_u64 vcc, v[66:67], v[94:95]
    s_mov_b64 exec, -1
    s_ff0_i32_b64 s68, vcc
    s_waitcnt lgkmcnt(0)
    v_cmpx_eq_u64 vcc, v[96:97], v[100:101]
    v_cmpx_eq_u64 vcc, v[98:99], v[102:103]
    v_cmpx_eq_u64 vcc, v[96:97], v[104:105]
    v_cmpx_eq_u64 vcc, v[98:99], v[106:107]
    v_cmpx_eq_u64 vcc, v[96:97], v[108:109]
    v_cmpx_eq_u64 vcc, v[98:99], v[110:111]
    v_cmpx_eq_u64 vcc, v[96:97], v[112:113]
    v_cmpx_eq_u64 vcc, v[98:99], v[114:115]
    v_cmpx_eq_u64 vcc, v[96:97], v[116:117]
    v_cmpx_eq_u64 vcc, v[98:99], v[118:119]
    v_cmpx_eq_u64 vcc, v[96:97], v[120:121]
    v_cmpx_eq_u64 vcc, v[98:99], v[122:123]
    v_cmpx_eq_u64 vcc, v[96:97], v[124:125]
    v_cmpx_eq_u64 vcc, v[98:99], v[126:127]
    s_mov_b64 exec, -1
    s_ff0_i32_b64 s69, vcc
    s_add_u32 s70, s69, 64
    s_cmp_lt_i32 s69, 0
    s_cselect_b32 s70, 128, s70
    s_cmp_lt_i32 s68, 0
    s_cselect_b32 s70, s70, s68
    s_lshl_b32 s70, s70, 2
    s_min_u32 s49, s70, s71
    s_barrier
    v_max_u32 v34, s49, v10
    v_subrev_u32 v34, s49, v34
    s_mul_i32 s69, s49, 547
    s_nop 0
    v_add_u32_dpp v34, v34, v34 row_shr:2 row_mask:0xf bank_mask:0xf
    s_nop 1
    v_add_u32_dpp v34, v34, v34 row_shr:4 row_mask:0xf bank_mask:0xf
    s_nop 1
    v_add_u32_dpp v34, v34, v34 row_shr:8 row_mask:0xf bank_mask:0xf
    s_nop 0
    v_readlane_b32 s39, v34, 14
    v_readlane_b32 s32, v34, 0
    v_readlane_b32 s33, v34, 2
    v_readlane_b32 s34, v34, 4
    v_readlane_b32 s35, v34, 6
    v_readlane_b32 s36, v34, 8
    v_readlane_b32 s37, v34, 10
    v_readlane_b32 s38, v34, 12
    s_add_u32 s48, s49, s39
    s_sub_u32 s61, s39, s38
    s_add_u32 s68, s49, s38
    s_lshl_b32 s68, s68, 4
    v_mul_u32_u24 v32, s68, v1
    v_cvt_f32_u32 v11, s48
    v_cmp_gt_u32 vcc, s69, v32
    v_rcp_f32 v11, v11
    s_mul_i32 s13, s48, 16
    s_lshr_b32 s13, s13, 8
    s_bcnt1_i32_b64 s31, vcc
    s_max_u32 s31, s31, 4
    s_min_u32 s31, s31, 32
    s_mul_i32 s12, s31, s13
    s_lshl_b32 s68, s48, 5
    s_add_u32 s12, s12, s68
    s_mul_i32 s1, s48, 20
    s_lshr_b32 s1, s1, 8
    s_add_u32 s12, s12, s1
    s_lshl_b32 s1, s1, 5
    s_lshl_b32 s13, s13, 5
    v_min_u32 v34, s31, v1
    v_mul_u32_u24 v34, s13, v34
    v_min_u32 v35, 1, v1
    v_mad_u32_u24 v34, v35, s1, v34
    v_mul_u32_u24 v22, s12, v1
    v_sub_u32 v22, v22, v34
    v_lshrrev_b32 v22, 10, v22
    v_mul_u32_u24 v34, s61, v22
    v_cvt_f32_u32 v6, v34
    v_mul_f32 v6, v11, v6
    v_cvt_u32_f32 v6, v6
    v_mul_u32_u24 v35, s48, v6
    v_sub_u32 v34, v34, v35
    v_cmp_le_i32 vcc, s48, v34
    v_ashrrev_i32 v34, 31, v34
    v_subrev_u32 v22, s49, v22
    v_addc_co_u32 v6, vcc, v34, v6, vcc
    v_sub_u32 v22, v22, v6
    s_add_u32 s69, s29, 1
    v_readlane_b32 s57, v6, 1
    v_readlane_b32 s50, v6, s29
    v_readlane_b32 s0, v6, s69
    v_readlane_b32 s51, v22, s29
    v_readlane_b32 s52, v22, s69
    s_sub_u32 s41, s32, 512
    s_sub_u32 s42, s33, 1024
    s_sub_u32 s43, s34, 1536
    s_sub_u32 s44, s35, 2048
    s_sub_u32 s45, s36, 2560
    s_sub_u32 s46, s37, 3072
    s_sub_u32 s47, s38, 3584
    s_sub_u32 s0, s0, s50
    s_sub_u32 s51, s51, s0
    s_sub_u32 s52, s52, s51
    s_add_u32 s50, s50, s38
    s_sub_u32 s59, s52, s0
    s_cmp_lt_u32 s62, s59
    s_cselect_b32 s62, s62, 0
    s_add_u32 s51, s51, s62
    s_sub_u32 s58, s52, s62
    s_sub_u32 s68, 31, s29
    s_mul_i32 s68, s68, s57
    s_add_u32 s50, s50, s68
    s_mul_i32 s56, s29, 1
    s_add_u32 s56, s56, s38
    v_mov_b32 v3, v1
    v_mov_b32 v36, 149504
    v_lshl_add_u32 v37, v1, 2, v36
    s_mov_b32 s53, 0
    s_barrier
L_hmap:
    v_subrev_u32 v12, s0, v3
    v_or_b32 v13, 7, v12
    v_cmp_gt_u32 vcc, s59, v13
    v_bfe_u32 v13, v12, 1, 2
    v_and_b32 v14, 1, v12
    v_lshl_or_b32 v13, v14, 2, v13
    v_and_or_b32 v13, v12, -8, v13
    v_cndmask_b32 v12, v12, v13, vcc
    v_add_u32 v14, s0, v12
    v_cmp_le_u32 vcc, s58, v14
    v_add_u32 v12, s51, v14
    v_subrev_u32 v13, s59, v12
    v_cndmask_b32 v12, v12, v13, vcc
    v_cmp_gt_u32 vcc, s0, v3
    v_add_u32 v13, s50, v3
    s_nop 0
    v_cndmask_b32 v12, v12, v13, vcc
    v_cmp_gt_u32 vcc, s57, v3
    v_lshl_add_u32 v13, v3, 5, s56
    s_nop 0
    v_cndmask_b32 v12, v12, v13, vcc
    v_mov_b32 v13, 0
    v_add_u32 v14, s49, v12
    v_cmpx_le_i32 vcc, s32, v12
    v_mov_b32 v13, s41
    v_cmpx_le_i32 vcc, s33, v12
    v_mov_b32 v13, s42
    v_cmpx_le_i32 vcc, s34, v12
    v_mov_b32 v13, s43
    v_cmpx_le_i32 vcc, s35, v12
    v_mov_b32 v13, s44
    v_cmpx_le_i32 vcc, s36, v12
    v_mov_b32 v13, s45
    v_cmpx_le_i32 vcc, s37, v12
    v_mov_b32 v13, s46
    v_cmpx_le_i32 vcc, s38, v12
    v_mov_b32 v13, s47
    s_mov_b64 exec, -1
    v_sub_u32 v13, v14, v13
    v_and_b32 v13, 4095, v13
    v_lshl_add_u32 v15, v13, 2, s10
    ds_read_b32 v16, v15
    v_cmp_le_i32 vcc, 0, v12
    v_lshrrev_b32 v14, 9, v13
    v_and_b32 v13, 511, v13
    v_lshl_add_u32 v14, v14, 1, 2
    v_and_b32 v14, 14, v14
    v_cndmask_b32 v14, 1, v14, vcc
    v_lshlrev_b32 v13, 4, v13
    v_lshl_add_u32 v17, v14, 16, v13
    s_waitcnt lgkmcnt(0)
    v_lshlrev_b32 v16, 16, v16
    ds_write_b32 v37, v17 offset:832
    ds_write_b32 v37, v16 offset:64
    s_cmp_lg_u32 s53, 0
    s_cbranch_scc1 L_hmore
    v_cmp_ne_u32 s[64:65], v17, v9
    v_cmp_ne_u32 vcc, v16, v8
    s_cmp_lt_u32 s52, 20
    s_cselect_b32 s69, 1, 0
    s_or_b32 s68, vcc_lo, s64
    s_and_b32 s68, s68, 0x3ffff
    s_or_b32 s55, s68, s69
    v_mov_b32 v38, s52
    v_mov_b32 v39, s55
    ds_write_b64 v36, v[38:39]
    v_mov_b32 v40, s0
    ds_write_b32 v36, v40 offset:12
L_hmore:
    s_add_u32 s53, s53, 64
    v_add_u32 v3, 64, v3
    v_add_u32 v37, 256, v37
    s_cmp_lt_u32 s53, s52
    s_cbranch_scc1 L_hmap
    s_waitcnt lgkmcnt(0)
    s_barrier
    s_cmp_ge_u32 s29, 4
    s_cbranch_scc1 L_hnoann2
    s_xor_b32 s68, s11, 8
    s_lshl_b32 s70, s29, 2
    s_lshl_b32 s68, s68, s70
    s_waitcnt vmcnt(0)
    v_mov_b32 v5, s68
    s_mov_b64 exec, 1
    global_atomic_add v4, v5, s[16:17]
    s_mov_b64 exec, -1
L_hnoann2:
    v_add_u32 v3, 1, v1
    v_min_u32 v34, s31, v3
    v_mul_u32_u24 v34, s13, v34
    v_min_u32 v35, 1, v3
    v_mad_u32_u24 v34, v35, s1, v34
    v_mul_u32_u24 v23, s12, v3
    v_sub_u32 v23, v23, v34
    v_lshrrev_b32 v23, 10, v23
    v_mul_u32_u24 v34, s61, v23
    v_cvt_f32_u32 v7, v34
    v_mul_f32 v7, v11, v7
    v_cvt_u32_f32 v7, v7
    v_mul_u32_u24 v35, s48, v7
    v_sub_u32 v34, v34, v35
    v_cmp_le_i32 vcc, s48, v34
    v_ashrrev_i32 v34, 31, v34
    v_subrev_u32 v23, s49, v23
    v_addc_co_u32 v7, vcc, v34, v7, vcc
    v_sub_u32 v23, v23, v7
    v_cmp_gt_i32 s[66:67], 0, v22
    v_cmp_lt_i32 s[64:65], v22, v23
    v_mov_b32 v18, 0
    s_nop 0
    s_and_b32 s74, s64, s66
    s_andn2_b32 s75, s64, s66
    v_cmp_lt_u32 s[64:65], v6, v7
    s_nop 0
    s_andn2_b32 s68, s64, s74
    v_writelane_b32 v18, s68, 15
    v_cmp_gt_i32 s[64:65], s32, v22
    s_nop 0
    s_and_b32 s68, s64, s75
    v_writelane_b32 v18, s68, 8
    v_cmp_gt_i32 s[64:65], s33, v22
    v_cmp_lt_i32 s[66:67], s32, v23
    s_and_b32 s68, s64, s75
    s_and_b32 s68, s68, s66
    v_writelane_b32 v18, s68, 9
    v_cmp_gt_i32 s[64:65], s34, v22
    v_cmp_lt_i32 s[66:67], s33, v23
    s_and_b32 s68, s64, s75
    s_and_b32 s68, s68, s66
    v_writelane_b32 v18, s68, 10
    v_cmp_gt_i32 s[64:65], s35, v22
    v_cmp_lt_i32 s[66:67], s34, v23
    s_and_b32 s68, s64, s75
    s_and_b32 s68, s68, s66
    v_writelane_b32 v18, s68, 11
    v_cmp_gt_i32 s[64:65], s36, v22
    v_cmp_lt_i32 s[66:67], s35, v23
    s_and_b32 s68, s64, s75
    s_and_b32 s68, s68, s66
    v_writelane_b32 v18, s68, 12
    v_cmp_gt_i32 s[64:65], s37, v22
    v_cmp_lt_i32 s[66:67], s36, v23
    s_and_b32 s68, s64, s75
    s_and_b32 s68, s68, s66
    v_writelane_b32 v18, s68, 13
    v_cmp_gt_i32 s[64:65], s38, v22
    v_cmp_lt_i32 s[66:67], s37, v23
    s_and_b32 s68, s64, s75
    s_and_b32 s68, s68, s66
    v_writelane_b32 v18, s68, 14
    v_lshrrev_b32 v14, s29, v18
    v_and_b32 v14, 1, v14
    v_cmp_eq_u32 vcc, 1, v14
    s_nop 0
    s_lshr_b32 s63, vcc_lo, 8
    s_bitcmp1_b32 s74, s29
    s_cselect_b32 s63, 0xff, s63
    s_cselect_b32 s77, 1, 2
    s_cmp_ge_u32 s52, 20
    s_cselect_b32 s77, s77, 0
    v_writelane_b32 v18, s63, 4
    v_writelane_b32 v18, s77, 5
    v_writelane_b32 v18, s74, 6
    v_lshl_add_u32 v37, v1, 2, v36
    s_mov_b64 exec, 0xfff0
    ds_write_b32 v37, v18
    s_mov_b64 exec, -1
    s_waitcnt lgkmcnt(0)
    s_barrier
    s_cmp_eq_u32 s77, 0
    s_cbranch_scc1 L_hend
    s_cmp_eq_u32 s55, 0
    s_cselect_b32 s53, 7, 0
    v_mov_b32 v36, 149512
    v_mov_b32 v37, 2
    ds_write_b32 v36, v37
    s_add_u32 s38, s52, 1
    s_andn2_b32 s38, s38, 1
    s_cmp_eq_u32 s29, 0
    s_cselect_b32 s68, s1, 0
    s_add_u32 s68, s68, s13
    s_lshr_b32 s68, s68, 10
    s_add_u32 s68, s68, 1
    s_cmp_lt_u32 s29, s31
    s_cselect_b32 s68, s68, 0
    s_add_u32 s68, s68, s52
    s_bitcmp1_b32 s52, 0
    s_cselect_b32 s69, 6, 0
    s_lshl2_add_u32 s68, s68, s69
    v_cvt_f32_u32 v38, s68
    v_cvt_f32_u32 v39, s12
    v_rcp_f32 v38, v38
    s_sub_u32 s38, s38, 5
    v_mul_f32 v38, v38, v39
    v_mul_f32 v38, 0x41000000, v38
    v_cvt_u32_f32 v38, v38
    s_mov_b32 s43, 0
    v_readfirstlane_b32 s35, v38
    s_mov_b32 s34, 0
    v_mov_b32 v40, v20
    s_mov_b64 s[36:37], 0
    s_lshl_b32 s40, -1, s31
    s_lshl_b32 s70, 1, s29
    s_and_b32 s70, s70, s40
    s_cmp_eq_u32 s29, 16
    s_addc_u32 s70, s70, 0
    s_sub_u32 s42, s38, 4
    s_lshr_b32 s44, s29, 2
    s_add_u32 s44, s44, 20
    v_mov_b32 v24, -1
    v_mov_b32 v25, -1
    v_mov_b32 v26, -1
    v_mov_b32 v27, -1
    v_lshlrev_b32 v32, 4, v1
    s_mov_b32 s45, 0
    s_mov_b32 s46, 0
    s_mov_b32 s41, 0
    s_mov_b32 s47, 0
    s_mov_b32 s32, 0
    s_lshl_b32 s33, 1, s11
    s_mov_b32 s88, s20
    s_mov_b32 s89, s21
    s_mov_b32 s90, s22
    s_mov_b32 s91, s23
    s_mov_b32 s92, s24
    s_mov_b32 s93, s25
    s_mov_b32 s94, s26
    s_mov_b32 s95, s27
    s_and_b32 s68, s11, 7
    s_lshl_b32 s68, s68, 8
    s_add_u32 s68, s68, 8390656
    v_mov_b32 v42, s68
L_hstep:
    s_cmp_ge_i32 s53, s38
    s_cbranch_scc1 L_hlast
    s_barrier
    s_cmp_eq_u32 s29, 16
    s_cbranch_scc1 L_hrelay
L_hrelayd:
    s_getreg_b32 s68, hwreg(HW_REG_IB_STS, 0, 4)
    s_cmp_lg_u32 s68, 0
    s_cbranch_scc1 L_hnoq
    s_waitcnt vmcnt(0)
    v_cmp_ne_u32 vcc, v40, v20
    v_readlane_b32 s66, v40, 0
    v_subrev_u32 v41, s34, v40
    buffer_load_dword v40, v21, s[84:87], 0 offen nt
    s_mul_i32 s34, s53, s35
    s_or_b32 s36, s36, vcc_lo
    s_and_b32 s64, s36, s40
    s_mov_b32 s65, 0
    s_cmp_eq_u32 s70, 0
    s_cbranch_scc1 L_hnopost
    v_mov_b32 v39, s34
    s_add_u32 s68, s46, 0x40000000
    v_writelane_b32 v39, s68, 0
    s_mov_b32 exec_lo, s70
    s_mov_b32 exec_hi, 0
    buffer_store_dword v39, v21, s[84:87], 0 offen
    s_mov_b64 exec, -1
L_hnopost:
    v_cndmask_b32 v41, 0, v41, s[64:65]
    s_bcnt1_i32_b32 s71, s64
    s_cmp_lt_u32 s71, 8
    s_cbranch_scc1 L_hnord
    v_cvt_f32_u32 v38, s71
    v_add_u32_dpp v41, v41, v41 row_shr:1 row_mask:0xf bank_mask:0xf
    v_rcp_f32 v38, v38
    s_nop 0
    v_add_u32_dpp v41, v41, v41 row_shr:2 row_mask:0xf bank_mask:0xf
    s_nop 1
    v_add_u32_dpp v41, v41, v41 row_shr:4 row_mask:0xf bank_mask:0xf
    s_nop 1
    v_add_u32_dpp v41, v41, v41 row_shr:8 row_mask:0xf bank_mask:0xf
    s_nop 1
    v_readlane_b32 s68, v41, 15
    v_readlane_b32 s69, v41, 31
    s_sub_u32 s66, s66, 0x40000000
    s_add_u32 s68, s68, s69
    v_cvt_f32_i32 v39, s68
    v_mul_f32 v39, v39, v38
    v_cvt_i32_f32 v39, v39
    s_bitcmp1_b32 s36, 0
    v_readfirstlane_b32 s45, v39
    s_cselect_b32 s66, s66, 0
    s_add_u32 s68, s45, s66
    s_cmp_ge_i32 s53, s42
    s_cselect_b32 s64, 1638, 0
    s_add_u32 s68, s68, s64
    s_mov_b32 s69, 0
    s_cmp_gt_i32 s68, -3789
    s_addc_u32 s69, s69, 0
    s_cmp_gt_i32 s68, -2253
    s_addc_u32 s69, s69, 0
    s_cmp_gt_i32 s68, -717
    s_addc_u32 s69, s69, 0
    s_cmp_gt_i32 s68, 819
    s_addc_u32 s69, s69, 0
    s_cmp_gt_i32 s68, 2867
    s_addc_u32 s69, s69, 0
    v_mov_b32 v37, s69
    ds_write_b32 v36, v37
    s_cmp_lg_u32 s29, 16
    s_cbranch_scc1 L_hnord
    s_cmp_lt_u32 s53, s32
    s_cbranch_scc1 L_hnord
    s_add_u32 s32, s53, 1
    s_add_u32 s68, s34, s45
    v_mov_b32 v43, s68
    s_mov_b64 exec, 1
    buffer_store_dword v43, v42, s[84:87], 0 offen sc1
    s_mov_b64 exec, -1
L_hnord:
    s_cmp_lt_u32 s53, s44
    s_cbranch_scc1 L_hnoq
    s_call_b64 s[4:5], L_hoff
L_hnoq:
    s_add_u32 s53, s53, 1
    s_branch L_hstep
L_hlast:
    v_mov_b32 v37, 5
    ds_write_b32 v36, v37
L_hrest:
    s_cmp_eq_u32 s43, 3
    s_cbranch_scc1 L_hdone
    s_waitcnt vmcnt(0)
    s_call_b64 s[4:5], L_hoff
    s_branch L_hrest
L_hdone:
    s_waitcnt lgkmcnt(0)
    s_barrier
    s_barrier
L_hend:
    s_endpgm
L_hrelay:
    s_add_u32 s68, s53, 4
    s_cmp_ge_i32 s68, s38
    s_cbranch_scc1 L_hrelayd
    s_getreg_b32 s68, hwreg(HW_REG_IB_STS, 8, 4)
    s_cmp_lg_u32 s68, 0
    s_cbranch_scc1 L_hrelayd
    s_waitcnt lgkmcnt(0)
    s_mov_b32 s69, 0
    s_cmp_lg_u32 s88, s20
    s_cselect_b32 s68, 1, 0
    s_or_b32 s33, s33, s68
    s_cmp_lg_u32 s11, 0
    s_cselect_b32 s68, s88, 0
    s_add_u32 s69, s69, s68
    s_cmp_lg_u32 s89, s21
    s_cselect_b32 s68, 2, 0
    s_or_b32 s33, s33, s68
    s_cmp_lg_u32 s11, 1
    s_cselect_b32 s68, s89, 0
    s_add_u32 s69, s69, s68
    s_cmp_lg_u32 s90, s22
    s_cselect_b32 s68, 4, 0
    s_or_b32 s33, s33, s68
    s_cmp_lg_u32 s11, 2
    s_cselect_b32 s68, s90, 0
    s_add_u32 s69, s69, s68
    s_cmp_lg_u32 s91, s23
    s_cselect_b32 s68, 8, 0
    s_or_b32 s33, s33, s68
    s_cmp_lg_u32 s11, 3
    s_cselect_b32 s68, s91, 0
    s_add_u32 s69, s69, s68
    s_cmp_lg_u32 s92, s24
    s_cselect_b32 s68, 16, 0
    s_or_b32 s33, s33, s68
    s_cmp_lg_u32 s11, 4
    s_cselect_b32 s68, s92, 0
    s_add_u32 s69, s69, s68
    s_cmp_lg_u32 s93, s25
    s_cselect_b32 s68, 32, 0
    s_or_b32 s33, s33, s68
    s_cmp_lg_u32 s11, 5
    s_cselect_b32 s68, s93, 0
    s_add_u32 s69, s69, s68
    s_cmp_lg_u32 s94, s26
    s_cselect_b32 s68, 64, 0
    s_or_b32 s33, s33, s68
    s_cmp_lg_u32 s11, 6
    s_cselect_b32 s68, s94, 0
    s_add_u32 s69, s69, s68
    s_cmp_lg_u32 s95, s27
    s_cselect_b32 s68, 128, 0
    s_or_b32 s33, s33, s68
    s_cmp_lg_u32 s11, 7
    s_cselect_b32 s68, s95, 0
    s_add_u32 s69, s69, s68
    s_load_dword s88, s[14:15], 0 glc
    s_load_dword s89, s[14:15], 256 glc
    s_load_dword s90, s[14:15], 512 glc
    s_load_dword s91, s[14:15], 768 glc
    s_load_dword s92, s[14:15], 1024 glc
    s_load_dword s93, s[14:15], 1280 glc
    s_load_dword s94, s[14:15], 1536 glc
    s_load_dword s95, s[14:15], 1792 glc
    s_mul_i32 s68, s47, 7
    s_sub_u32 s69, s69, s68
    s_mul_i32 s47, s53, s35
    s_add_u32 s47, s47, s45
    s_cmp_lg_u32 s33, 0xff
    s_cbranch_scc1 L_hrelayd
    s_mul_i32 s69, s69, 73
    s_ashr_i32 s69, s69, 9
    s_add_u32 s69, s69, 3072
    s_mul_i32 s69, s69, 5
    s_ashr_i32 s69, s69, 3
    s_sub_u32 s69, s69, s46
    s_ashr_i32 s69, s69, 0
    s_add_u32 s46, s46, s69
    s_branch L_hrelayd
L_hoff:
    s_add_u32 s43, s43, 1
    s_cmp_eq_u32 s43, 2
    s_cbranch_scc1 L_hoff2
    s_cmp_eq_u32 s43, 3
    s_cbranch_scc1 L_hoff3
    global_load_dword v5, v4, s[16:17] sc1
    s_mov_b32 s71, s63
    s_mul_i32 s64, s28, 1152
    s_mul_i32 s68, s29, 9216
    s_add_u32 s64, s64, s68
    v_lshlrev_b32 v38, 7, v1
    s_mov_b32 exec_lo, 0x1ff
    s_mov_b32 exec_hi, 0x0
L_htoucha:
    s_ff1_i32_b32 s68, s71
    s_bitset0_b32 s71, s68
    s_mul_i32 s68, s68, 294912
    s_add_u32 s68, s68, s64
    buffer_load_dword v145, v38, s[84:87], s68 offen sc1
    s_cmp_lg_u32 s71, 0
    s_cbranch_scc1 L_htoucha
    s_mov_b64 exec, -1
    s_setpc_b64 s[4:5]
L_hoff2:
    v_readfirstlane_b32 s68, v5
    s_xor_b32 s69, s11, 8
    s_mul_i32 s69, s69, 0x1111
    s_cmp_eq_u32 s68, s69
    s_cselect_b32 s3, 1, 0
    s_cmp_lt_u32 s11, 8
    s_cselect_b32 s3, s3, 0
    v_mov_b32 v38, s3
    ds_write_b32 v36, v38 offset:20
    s_mul_i32 s69, s28, 1152
    s_mul_i32 s68, s29, 9216
    s_add_u32 s69, s69, s68
    s_mov_b32 s71, s63
    s_cmp_eq_u32 s3, 0
    s_cbranch_scc1 L_hmarkg
L_hmarkl:
    s_ff1_i32_b32 s68, s71
    s_bitset0_b32 s71, s68
    s_mul_i32 s68, s68, 294912
    s_add_u32 s68, s68, s69
    s_cmp_eq_u32 s77, 1
    s_cbranch_scc1 L_hrowl
    buffer_store_dwordx4 v[24:27], v32, s[84:87], s68 offen
L_hrowl:
    s_mov_b64 exec, 0xff
    buffer_store_dwordx4 v[24:27], v32, s[84:87], s68 offen offset:1024
    s_mov_b64 exec, -1
    s_cmp_lg_u32 s71, 0
    s_cbranch_scc1 L_hmarkl
    s_setpc_b64 s[4:5]
L_hmarkg:
    s_ff1_i32_b32 s68, s71
    s_bitset0_b32 s71, s68
    s_mul_i32 s68, s68, 294912
    s_add_u32 s68, s68, s69
    s_cmp_eq_u32 s77, 1
    s_cbranch_scc1 L_hrowg
    buffer_store_dwordx4 v[24:27], v32, s[84:87], s68 offen sc1
L_hrowg:
    s_mov_b64 exec, 0xff
    buffer_store_dwordx4 v[24:27], v32, s[84:87], s68 offen offset:1024 sc1
    s_mov_b64 exec, -1
    s_cmp_lg_u32 s71, 0
    s_cbranch_scc1 L_hmarkg
    s_setpc_b64 s[4:5]
L_hoff3:
    s_cmp_eq_u32 s3, 0
    s_cbranch_scc1 L_hoff4
    s_lshl_b32 exec_lo, 1, s29
    s_mov_b32 exec_hi, 0
    buffer_store_dword v24, v63, s[84:87], 0 offen
    s_mov_b64 exec, -1
    s_branch L_hoff5
L_hoff4:
    s_lshl4_add_u32 s68, s28, 128
    v_lshrrev_b32 v34, 1, v1
    v_lshl_add_u32 v34, v34, 2, s68
    v_and_b32 v35, 1, v1
    v_lshlrev_b32 v35, 4, v35
    v_lshlrev_b32 v35, v35, 1
    s_mov_b32 exec_lo, s63
    s_mov_b32 exec_hi, 0
    global_atomic_add v34, v35, s[16:17]
    s_mov_b64 exec, -1
L_hoff5:
    s_or_b32 s68, s3, 2
    v_mov_b32 v38, s68
    ds_write_b32 v36, v38 offset:20
    s_mov_b32 s44, -1
    s_setpc_b64 s[4:5]
.p2align 6
.type L_first,@object
L_first:
    .long 134217728, 136314880, 138412032, 140509184, 1544, -257, 4, 1420, 47, 46, 3, 255, 0, 0, 0, 0
    .long 134283264, 136380416, 138477568, 140574720, 1544, -199, 5, 1421, 39, 50, 16, 255, 0, 0, 0, 0
    .long 134348800, 136445952, 138543104, 140640256, 1545, -165, 5, 1422, 55, 50, 0, 255, 0, 0, 0, 0
    .long 134414336, 136511488, 138608640, 140705792, 1546, -91, 5, 1423, 30, 49, 24, 255, 0, 0, 0, 0
    .long 134479872, 136577024, 138674176, 140771328, 1547, -66, 5, 1424, 55, 50, 0, 255, 0, 0, 0, 0
    .long 134545408, 136642560, 138739712, 140836864, 1548, 26, 5, 1425, 13, 50, 42, 255, 0, 0, 0, 0
    .long 134610944, 136708096, 138805248, 140902400, 1549, 39, 5, 1426, 54, 54, 5, 129, 0, 0, 0, 0
    .long 134676480, 136773632, 138870784, 140967936, 1550, 123, 6, 1427, 22, 52, 36, 129, 0, 0, 0, 0
    .long 134742016, 136839168, 138936320, 141033472, 1552, 140, 5, 1428, 58, 53, 0, 129, 0, 0, 0, 0
    .long 134807552, 136904704, 139001856, 141099008, 1553, 231, 5, 1429, 21, 54, 38, 131, 0, 0, 0, 0
    .long 134873088, 136970240, 139067392, 141164544, 1554, 246, 6, 1430, 58, 52, 0, 130, 0, 0, 0, 0
    .long 134938624, 137035776, 139132928, 141230080, 1556, 299, 5, 1431, 59, 54, 0, 130, 0, 0, 0, 0
    .long 135004160, 137101312, 139198464, 141295616, 1557, 353, 5, 1432, 58, 53, 0, 130, 0, 0, 0, 0
    .long 135069696, 137166848, 139264000, 141361152, 1558, 418, 6, 1433, 46, 53, 13, 134, 0, 0, 0, 0
    .long 135135232, 137232384, 139329536, 141426688, 1560, 459, 5, 1434, 58, 53, 0, 132, 0, 0, 0, 0
    .long 135200768, 137297920, 139395072, 141492224, 1561, 512, 5, 1435, 58, 53, 0, 132, 0, 0, 0, 0
    .long 135266304, 137363456, 139460608, 141557760, 1562, 567, 6, 1436, 56, 53, 3, 140, 0, 0, 0, 0
    .long 135331840, 137428992, 139526144, 141623296, 1564, 618, 5, 1437, 58, 53, 0, 136, 0, 0, 0, 0
    .long 135397376, 137494528, 139591680, 141688832, 1565, 718, 5, 1438, 12, 54, 47, 136, 0, 0, 0, 0
    .long 135462912, 137560064, 139657216, 141754368, 1566, 760, 6, 1439, 22, 52, 36, 152, 0, 0, 0, 0
    .long 135528448, 137625600, 139722752, 141819904, 1568, 790, 5, 1440, 46, 54, 13, 144, 0, 0, 0, 0
    .long 135593984, 137691136, 139788288, 141885440, 1569, 869, 5, 1441, 20, 53, 38, 144, 0, 0, 0, 0
    .long 135659520, 137756672, 139853824, 141950976, 1570, 883, 6, 1442, 59, 53, 0, 144, 0, 0, 0, 0
    .long 135725056, 137822208, 139919360, 142016512, 1572, 973, 5, 1443, 22, 53, 36, 144, 0, 0, 0, 0
    .long 135790592, 137887744, 139984896, 142082048, 1573, 1027, 5, 1444, 21, 53, 37, 176, 0, 0, 0, 0
    .long 135856128, 137953280, 140050432, 142147584, 1574, 1047, 6, 1445, 54, 53, 5, 160, 0, 0, 0, 0
    .long 135921664, 138018816, 140115968, 142213120, 1576, 1096, 5, 1446, 58, 53, 0, 160, 0, 0, 0, 0
    .long 135987200, 138084352, 140181504, 142278656, 1577, 1155, 5, 1447, 53, 54, 6, 160, 0, 0, 0, 0
    .long 136052736, 138149888, 140247040, 142344192, 1578, 1216, 5, 1448, 45, 53, 13, 224, 0, 0, 0, 0
    .long 136118272, 138215424, 140312576, 142409728, 1579, 1255, 6, 1449, 59, 53, 0, 192, 0, 0, 0, 0
    .long 136183808, 138280960, 140378112, 142475264, 1581, 1309, 5, 1450, 58, 53, 0, 192, 0, 0, 0, 0
    .long 136249344, 138346496, 140443648, 142540800, 1582, 1365, 6, 1451, 55, 53, 4, 192, 0, 0, 0, 0
.size L_first, 2048
.section .rodata,"a"
.p2align 6
.amdhsa_kernel standalone__paged_block_table_kv_radixattention__sampling_kernel
  .amdhsa_next_free_vgpr 152
  .amdhsa_next_free_sgpr 102
  .amdhsa_accum_offset 152
  .amdhsa_group_segment_fixed_size 0
  .amdhsa_kernarg_size 64
  .amdhsa_user_sgpr_count 2
  .amdhsa_user_sgpr_kernarg_segment_ptr 1
  .amdhsa_system_sgpr_workgroup_id_x 1
.end_amdhsa_kernel
```
